```python
import torch

def _softmax(x, axis=-1):
    return torch.softmax(x, dim=axis)
def _gelu(x):
    return torch.nn.functional.gelu(x, approximate="tanh")
def _silu(x):
    return torch.nn.functional.silu(x)
def _sigmoid(x):
    return torch.sigmoid(x)
def _layernorm(x, axis=-1, eps=1e-5):
    m = x.mean(dim=axis, keepdim=True)
    v = x.var(dim=axis, keepdim=True, unbiased=False)
    return (x - m) / torch.sqrt(v + eps)
def _scatter_add(tgt, idx, src, axis=0):
    return tgt.clone().index_add_(axis, idx, src)
def _segment_sum(src, seg, n):
    out = torch.zeros((n,) + src.shape[1:], dtype=src.dtype)
    return out.index_add_(0, seg, src)
def _pad(x, pw):
    flat = tuple(v for pair in reversed(pw) for v in pair)
    return torch.nn.functional.pad(x, flat)

kernel_name = 'recurrent_scan__ssm_conv_h3__mixer_s_mlp__prompt'

def setup_inputs():

    _w = (lambda a: (lambda t: t.to(torch.bfloat16) if t.is_floating_point() else t)(torch.as_tensor(a)))
    def _A_setup():
        B, S, D = 1, 2048, 512
        ks = 4
        return {
            "q": _w((lambda *s: torch.randn(*s, dtype=torch.bfloat16) * 0.05)(B, S, D)),
            "k": _w((lambda *s: torch.randn(*s, dtype=torch.bfloat16) * 0.2)(B, S, D)),
            "v": _w((lambda *s: torch.randn(*s, dtype=torch.bfloat16) * 0.2)(B, S, D)),
            "shift_k": _w((lambda *s: torch.randn(*s, dtype=torch.bfloat16) * 0.2)(D, ks) * 0.5),
            "ssm_k": _w((lambda *s: torch.randn(*s, dtype=torch.bfloat16) * 0.2)(D, S) * (1.0 / S ** 0.5)),
            "ssm_D": _w((lambda *s: torch.randn(*s, dtype=torch.bfloat16) * 0.2)(D)),
        }
    _A_in = _A_setup()

    def _B_setup():
        B, S, D, F = 1, 2048, 512, 1792
        return {
            "x":  _w((lambda *s: torch.randn(*s, dtype=torch.bfloat16) * 0.05)(B, S, D)),
            "w1": _w((lambda *s: torch.randn(*s, dtype=torch.bfloat16) * 3.2)(D, D) * (D ** -0.5)),
            "w2": _w((lambda *s: torch.randn(*s, dtype=torch.bfloat16) * 3.2)(D, D) * (D ** -0.5)),
            "w3": _w((lambda *s: torch.randn(*s, dtype=torch.bfloat16) * 3.2)(D, F) * (D ** -0.5)),
            "w4": _w((lambda *s: torch.randn(*s, dtype=torch.bfloat16) * 3.2)(F, D) * (F ** -0.5)),
        }
    _B_in = _B_setup()

    return {
        "A_q": _A_in["q"],
        "A_k": _A_in["k"],
        "A_v": _A_in["v"],
        "A_shift_k": _A_in["shift_k"],
        "A_ssm_k": _A_in["ssm_k"],
        "A_ssm_D": _A_in["ssm_D"],
        "B_x": _B_in["x"],
        "B_w1": _B_in["w1"],
        "B_w2": _B_in["w2"],
        "B_w3": _B_in["w3"],
        "B_w4": _B_in["w4"],
    }

def reference(A_q, A_k, A_v, A_shift_k, A_ssm_k, A_ssm_D, B_x, B_w1, B_w2, B_w3, B_w4):
    def _A_ref(q, k, v, shift_k, ssm_k, ssm_D):
        B, S, D = q.shape
        ks = shift_k.shape[-1]
        k_pad = _pad(k, ((0, 0), (ks - 1, 0), (0, 0)))
        k_shift = torch.zeros_like(k)
        for t in range(ks):
            k_shift = k_shift + k_pad[:, t:t + S, :] * shift_k[:, ks - 1 - t][None, None, :]
        kv = k_shift * v
        L = 2 * S
        kv_pad = _pad(kv, ((0, 0), (0, S), (0, 0)))
        kf_pad = _pad(ssm_k, ((0, 0), (0, S)))
        kv_f = (lambda x, axes=(-2,-1): torch.fft.rfft2(x.float(), dim=axes))(kv_pad[:, None, :, :], axes=(1, 2))
        kf_f = (lambda x, axes=(-2,-1): torch.fft.rfft2(x.float(), dim=axes))(kf_pad[:, None, :], axes=(1, 2))
        kf_f = (lambda x, *d: x.permute(*d))(kf_f, 1, 2, 0)
        y_f = kv_f * kf_f[None, :, :, :]
        y = (lambda x, s, axes=(-2,-1): torch.fft.irfft2(x, s=s, dim=axes).to(torch.bfloat16))(y_f, (1, L), axes=(1, 2))[:, 0, :S, :]
        y = y + kv * ssm_D[None, None, :]
        return q * y

    def _B_ref(x, w1, w2, w3, w4):
        B, S, D = x.shape
        h = _gelu(_layernorm(x, axis=-1) @ w1)
        c = D // 4
        g0 = _pad(h[:, :, 0*c:1*c], ((0, 0), (1, 0), (0, 0)))[:, :S, :]
        g1 = _pad(h[:, :, 1*c:2*c], ((0, 0), (0, 1), (0, 0)))[:, 1:, :]
        g2 = _pad(h[:, :, 2*c:3*c], ((0, 0), (2, 0), (0, 0)))[:, :S, :]
        g3 = _pad(h[:, :, 3*c:   ], ((0, 0), (0, 2), (0, 0)))[:, 2:, :]
        hs = torch.concatenate([g0, g1, g2, g3], axis=-1) @ w2
        x1 = x + hs
        h2 = _gelu(_layernorm(x1, axis=-1) @ w3) @ w4
        return x1 + h2

    x = A_q
    xn = _layernorm(x, axis=-1)
    s = _A_ref(xn, A_k, A_v, A_shift_k, A_ssm_k, A_ssm_D)
    g = _silu(_B_ref(xn, B_w1, B_w2, B_w3, B_w4))
    return x + s * g
```

```asm
; @launch grid=(256,1,1) block=(256,1,1) lds=163840
.amdgcn_target "amdgcn-amd-amdhsa--gfx950"
.text
.globl recurrent_scan__ssm_conv_h3__mixer_s_mlp__prompt_kernel
.p2align 8
.type recurrent_scan__ssm_conv_h3__mixer_s_mlp__prompt_kernel,@function
recurrent_scan__ssm_conv_h3__mixer_s_mlp__prompt_kernel:
s_cmp_ge_u32 s2, 256
s_cbranch_scc1 L_end
s_load_dwordx2 s[8:9], s[0:1], 0
s_load_dwordx2 s[20:21], s[0:1], 56
s_getpc_b64 s[70:71]
L_pc:
v_lshrrev_b32 v1, 6, v0
v_and_b32 v58, 63, v0
s_lshr_b32 s3, s2, 3
v_readfirstlane_b32 s4, v1
s_lshl_b32 s63, s3, 2
s_and_b32 s7, s2, 7
s_add_u32 s63, s63, s4
s_mul_i32 s63, s63, (L_end-L_pc+16383)/16384
v_add_u32 v1, s63, v58
v_min_u32 v1, (L_end-L_pc)/128, v1
v_lshlrev_b32 v1, 7, v1
s_mov_b32 exec_lo, (1<<((L_end-L_pc+16383)/16384))-1
s_mov_b32 exec_hi, 0
global_load_dword v255, v1, s[70:71]
s_mov_b64 exec, -1
s_lshr_b32 s5, s3, 3
s_lshl_b32 s63, s7, 2
s_add_u32 s5, s5, s63
s_and_b32 s6, s3, 7
v_lshrrev_b32 v57, 4, v58
v_lshrrev_b32 v1, 3, v58
v_and_b32 v2, 7, v0
v_lshlrev_b32 v1, 10, v1
v_xor_b32 v3, v2, v57
v_lshl_add_u32 v64, v3, 4, v1
v_xor_b32 v65, 64, v64
v_add_u32 v65, 7168, v65
v_and_b32 v3, 1, v57
v_lshlrev_b32 v3, 1, v3
v_xor_b32 v3, v3, v2
v_lshl_add_u32 v66, v3, 4, v1
v_xor_b32 v67, 64, v66
v_add_u32 v67, 7168, v67
s_lshl_b32 s64, s5, 16
s_lshl_b32 s63, s4, 14
s_add_u32 s64, s64, s63
s_lshl_b32 s65, s6, 7
s_add_u32 s65, s65, s63
s_lshl_b32 s66, s4, 11
s_mov_b32 s10, 2097152
s_mov_b32 s11, 0x20000
s_mov_b32 s22, 524288
s_mov_b32 s23, 0x20000
s_mov_b32 s67, 0
s_waitcnt lgkmcnt(0)
s_add_u32 s68, s67, s64
s_mov_b32 m0, s66
s_lshl_b32 s69, s67, 9
buffer_load_dwordx4 v64, s[8:11], s68 offen lds
buffer_load_dwordx4 v65, s[8:11], s68 offen offset:1024 lds
s_add_u32 m0, s66, 65536
s_add_u32 s69, s69, s65
buffer_load_dwordx4 v66, s[20:23], s69 offen lds
buffer_load_dwordx4 v67, s[20:23], s69 offen offset:1024 lds
s_add_u32 s66, s66, 8192
s_add_u32 s67, s67, 128
s_and_b32 s67, s67, 0x380
s_add_u32 s68, s67, s64
s_mov_b32 m0, s66
s_lshl_b32 s69, s67, 9
buffer_load_dwordx4 v64, s[8:11], s68 offen lds
buffer_load_dwordx4 v65, s[8:11], s68 offen offset:1024 lds
s_add_u32 m0, s66, 65536
s_add_u32 s69, s69, s65
buffer_load_dwordx4 v66, s[20:23], s69 offen lds
buffer_load_dwordx4 v67, s[20:23], s69 offen offset:1024 lds
s_add_u32 s66, s66, 8192
s_add_u32 s67, s67, 128
s_and_b32 s67, s67, 0x380
s_load_dwordx2 s[44:45], s[0:1], 104
s_load_dwordx2 s[48:49], s[0:1], 96
s_load_dwordx2 s[12:13], s[0:1], 8
s_load_dwordx2 s[16:17], s[0:1], 16
s_load_dwordx2 s[52:53], s[0:1], 24
s_load_dwordx2 s[36:37], s[0:1], 32
s_load_dwordx2 s[56:57], s[0:1], 40
s_load_dwordx2 s[24:25], s[0:1], 64
s_load_dwordx2 s[28:29], s[0:1], 72
s_load_dwordx2 s[32:33], s[0:1], 80
s_load_dwordx2 s[40:41], s[0:1], 88
s_lshr_b32 s78, s4, 1
s_and_b32 s79, s4, 1
v_and_b32 v56, 15, v0
v_bfe_u32 v59, v0, 2, 2
v_and_b32 v60, 3, v0
v_mov_b32 v61, 0x3f803f80
v_mov_b32 v62, 0
s_lshl_b32 s63, s78, 12
s_lshl_b32 s72, s79, 11
v_lshrrev_b32 v1, 1, v56
v_xor_b32 v1, v1, v57
v_lshlrev_b32 v1, 4, v1
v_lshl_add_u32 v1, v56, 7, v1
v_add_u32 v1, s63, v1
v_add_u32 v68, s72, v1
v_xor_b32 v70, 2048, v68
v_xor_b32 v69, 64, v68
v_xor_b32 v71, 64, v70
v_lshrrev_b32 v1, 1, v59
v_and_b32 v2, 1, v57
v_lshl_or_b32 v1, v2, 1, v1
v_lshlrev_b32 v1, 1, v1
v_lshrrev_b32 v2, 1, v60
v_xor_b32 v1, v1, v2
v_lshlrev_b32 v1, 4, v1
v_and_b32 v2, 1, v60
v_lshl_or_b32 v1, v2, 3, v1
v_lshl_add_u32 v2, v57, 3, v59
v_lshl_add_u32 v15, v2, 7, v1
s_lshl_b32 s72, s79, 6
v_xor_b32 v72, s72, v15
v_add_u32 v72, 65536, v72
v_xor_b32 v73, 32, v72
v_mov_b32 v76, v61
v_mov_b32 v77, v61
v_mov_b32 v78, v61
v_mov_b32 v79, v61
s_mov_b32 s46, 20971520
s_mov_b32 s47, 0x20000
s_mov_b32 s50, 256
s_mov_b32 s51, 0x20000
s_mov_b32 s14, 2097152
s_mov_b32 s15, 0x20000
s_mov_b32 s18, 2097152
s_mov_b32 s19, 0x20000
s_mov_b32 s54, 4096
s_mov_b32 s55, 0x20000
s_mov_b32 s38, 2097152
s_mov_b32 s39, 0x20000
s_mov_b32 s58, 1024
s_mov_b32 s59, 0x20000
s_mov_b32 s26, 524288
s_mov_b32 s27, 0x20000
s_mov_b32 s30, 1835008
s_mov_b32 s31, 0x20000
s_mov_b32 s34, 1835008
s_mov_b32 s35, 0x20000
s_mov_b32 s42, 2097152
s_mov_b32 s43, 0x20000
s_add_u32 s68, s67, s64
s_mov_b32 m0, s66
s_lshl_b32 s69, s67, 9
buffer_load_dwordx4 v64, s[8:11], s68 offen lds
buffer_load_dwordx4 v65, s[8:11], s68 offen offset:1024 lds
s_add_u32 m0, s66, 65536
s_add_u32 s69, s69, s65
buffer_load_dwordx4 v66, s[20:23], s69 offen lds
buffer_load_dwordx4 v67, s[20:23], s69 offen offset:1024 lds
s_add_u32 s66, s66, 8192
s_add_u32 s67, s67, 128
s_and_b32 s67, s67, 0x380
s_lshr_b32 s60, s7, 1
s_lshl_b32 s60, s60, 2
s_lshr_b32 s63, s3, 3
s_add_u32 s60, s60, s63
s_and_b32 s61, s7, 1
s_lshl_b32 s61, s61, 3
s_add_u32 s61, s61, s6
s_waitcnt lgkmcnt(0)
s_or_b32 s63, s2, s4
s_cmp_lg_u32 s63, 0
s_cbranch_scc1 L_init_1
v_lshlrev_b32 v1, 7, v0
v_add_u32 v2, 8192, v1
buffer_store_dword v62, v1, s[44:47], 0 offen sc1
buffer_store_dword v62, v2, s[44:47], 0 offen sc1
s_movk_i32 s63, 16384
buffer_store_dword v62, v1, s[44:47], s63 offen sc1
buffer_store_dword v62, v2, s[44:47], s63 offen sc1
v_mov_b32 v2, 1
s_waitcnt vmcnt(0)
s_mov_b64 exec, 1
buffer_store_dword v2, v62, s[48:51], 0 offen sc1
s_mov_b64 exec, -1
L_init_1:
s_waitcnt vmcnt(8)
s_barrier
ds_read_b128 v[108:111], v68 offset:0
ds_read_b128 v[112:115], v70 offset:0
ds_read_b64_tr_b16 v[124:125], v72 offset:0
ds_read_b64_tr_b16 v[126:127], v72 offset:512
ds_read_b64_tr_b16 v[128:129], v73 offset:0
ds_read_b64_tr_b16 v[130:131], v73 offset:512
ds_read_b128 v[116:119], v69 offset:0
ds_read_b128 v[120:123], v71 offset:0
ds_read_b64_tr_b16 v[132:133], v72 offset:4096
ds_read_b64_tr_b16 v[134:135], v72 offset:4608
ds_read_b64_tr_b16 v[136:137], v73 offset:4096
ds_read_b64_tr_b16 v[138:139], v73 offset:4608
s_waitcnt lgkmcnt(6)
v_mfma_f32_16x16x32_bf16 v[216:219], v[108:111], v[108:111], 0
s_add_u32 s68, s67, s64
s_mov_b32 m0, s66
s_lshl_b32 s69, s67, 9
buffer_load_dwordx4 v64, s[8:11], s68 offen lds
v_mfma_f32_16x16x32_bf16 v[212:215], v[76:79], v[108:111], 0
v_lshrrev_b32 v1, 3, v58
v_and_b32 v2, 7, v0
v_mfma_f32_16x16x32_bf16 v[96:99], v[124:127], v[76:79], 0
buffer_load_dwordx4 v65, s[8:11], s68 offen offset:1024 lds
v_mfma_f32_16x16x32_bf16 v[100:103], v[128:131], v[76:79], 0
v_lshlrev_b32 v1, 10, v1
v_lshl_add_u32 v1, v2, 4, v1
v_mfma_f32_16x16x32_bf16 v[80:83], v[124:127], v[108:111], 0
s_add_u32 m0, s66, 65536
s_add_u32 s69, s69, s65
buffer_load_dwordx4 v66, s[20:23], s69 offen lds
v_mfma_f32_16x16x32_bf16 v[84:87], v[128:131], v[108:111], 0
s_lshl_b32 s70, s5, 16
s_lshl_b32 s71, s6, 7
v_mfma_f32_16x16x32_bf16 v[88:91], v[124:127], v[112:115], 0
buffer_load_dwordx4 v67, s[20:23], s69 offen offset:1024 lds
s_add_u32 s66, s66, 8192
s_add_u32 s67, s67, 128
s_and_b32 s67, s67, 0x380
v_mfma_f32_16x16x32_bf16 v[92:95], v[128:131], v[112:115], 0
s_add_u32 s73, s70, s71
s_lshl_b32 s71, s4, 14
s_waitcnt lgkmcnt(0)
s_waitcnt vmcnt(8)
s_barrier
v_mfma_f32_16x16x32_bf16 v[216:219], v[116:119], v[116:119], v[216:219]
ds_read_b128 v[180:183], v68 offset:8192
ds_read_b128 v[184:187], v70 offset:8192
v_mfma_f32_16x16x32_bf16 v[212:215], v[76:79], v[116:119], v[212:215]
ds_read_b64_tr_b16 v[196:197], v72 offset:8192
ds_read_b64_tr_b16 v[198:199], v72 offset:8704
v_mfma_f32_16x16x32_bf16 v[96:99], v[132:135], v[76:79], v[96:99]
ds_read_b64_tr_b16 v[200:201], v73 offset:8192
ds_read_b64_tr_b16 v[202:203], v73 offset:8704
v_mfma_f32_16x16x32_bf16 v[100:103], v[136:139], v[76:79], v[100:103]
ds_read_b128 v[188:191], v69 offset:8192
ds_read_b128 v[192:195], v71 offset:8192
v_mfma_f32_16x16x32_bf16 v[80:83], v[132:135], v[116:119], v[80:83]
ds_read_b64_tr_b16 v[204:205], v72 offset:12288
ds_read_b64_tr_b16 v[206:207], v72 offset:12800
v_mfma_f32_16x16x32_bf16 v[84:87], v[136:139], v[116:119], v[84:87]
ds_read_b64_tr_b16 v[208:209], v73 offset:12288
ds_read_b64_tr_b16 v[210:211], v73 offset:12800
v_mfma_f32_16x16x32_bf16 v[88:91], v[132:135], v[120:123], v[88:91]
s_add_u32 s70, s73, s71
s_add_u32 s71, s70, 8192
v_mfma_f32_16x16x32_bf16 v[92:95], v[136:139], v[120:123], v[92:95]
s_lshl_b32 s63, s4, 11
s_lshl_b32 s76, s4, 5
s_waitcnt lgkmcnt(0)
v_mfma_f32_16x16x32_bf16 v[216:219], v[180:183], v[180:183], v[216:219]
s_add_u32 s68, s67, s64
s_mov_b32 m0, s66
s_lshl_b32 s69, s67, 9
buffer_load_dwordx4 v64, s[8:11], s68 offen lds
v_mfma_f32_16x16x32_bf16 v[212:215], v[76:79], v[180:183], v[212:215]
v_xor_b32 v4, s76, v1
v_xor_b32 v5, 16, v4
v_mfma_f32_16x16x32_bf16 v[96:99], v[196:199], v[76:79], v[96:99]
buffer_load_dwordx4 v65, s[8:11], s68 offen offset:1024 lds
v_mfma_f32_16x16x32_bf16 v[100:103], v[200:203], v[76:79], v[100:103]
s_add_u32 s72, s76, 32
s_and_b32 s72, s72, 0x70
v_mfma_f32_16x16x32_bf16 v[80:83], v[196:199], v[180:183], v[80:83]
s_add_u32 m0, s66, 65536
s_add_u32 s69, s69, s65
buffer_load_dwordx4 v66, s[20:23], s69 offen lds
v_mfma_f32_16x16x32_bf16 v[84:87], v[200:203], v[180:183], v[84:87]
v_xor_b32 v6, s72, v1
s_cmp_eq_u32 s5, 0
s_cselect_b32 s74, 0x7ff00000, 0
s_cselect_b32 s72, 0, 8192
v_mfma_f32_16x16x32_bf16 v[88:91], v[196:199], v[184:187], v[88:91]
buffer_load_dwordx4 v67, s[20:23], s69 offen offset:1024 lds
s_add_u32 s66, s66, 8192
s_add_u32 s67, s67, 128
s_and_b32 s67, s67, 0x380
v_mfma_f32_16x16x32_bf16 v[92:95], v[200:203], v[184:187], v[92:95]
s_sub_u32 s73, s73, s72
v_add_u32 v7, s74, v1
s_waitcnt vmcnt(8)
s_barrier
v_mfma_f32_16x16x32_bf16 v[216:219], v[188:191], v[188:191], v[216:219]
ds_read_b128 v[108:111], v68 offset:16384
ds_read_b128 v[112:115], v70 offset:16384
v_mfma_f32_16x16x32_bf16 v[212:215], v[76:79], v[188:191], v[212:215]
ds_read_b64_tr_b16 v[124:125], v72 offset:16384
ds_read_b64_tr_b16 v[126:127], v72 offset:16896
v_mfma_f32_16x16x32_bf16 v[96:99], v[204:207], v[76:79], v[96:99]
ds_read_b64_tr_b16 v[128:129], v73 offset:16384
ds_read_b64_tr_b16 v[130:131], v73 offset:16896
v_mfma_f32_16x16x32_bf16 v[100:103], v[208:211], v[76:79], v[100:103]
ds_read_b128 v[116:119], v69 offset:16384
ds_read_b128 v[120:123], v71 offset:16384
v_mfma_f32_16x16x32_bf16 v[80:83], v[204:207], v[188:191], v[80:83]
ds_read_b64_tr_b16 v[132:133], v72 offset:20480
ds_read_b64_tr_b16 v[134:135], v72 offset:20992
v_mfma_f32_16x16x32_bf16 v[84:87], v[208:211], v[188:191], v[84:87]
ds_read_b64_tr_b16 v[136:137], v73 offset:20480
ds_read_b64_tr_b16 v[138:139], v73 offset:20992
v_mfma_f32_16x16x32_bf16 v[88:91], v[204:207], v[192:195], v[88:91]
v_lshrrev_b32 v2, 3, v58
v_lshlrev_b32 v3, 4, v2
v_mfma_f32_16x16x32_bf16 v[92:95], v[208:211], v[192:195], v[92:95]
s_lshl_b32 s74, s6, 9
s_lshl_b32 s72, s4, 7
s_waitcnt lgkmcnt(0)
v_mfma_f32_16x16x32_bf16 v[216:219], v[108:111], v[108:111], v[216:219]
s_add_u32 s68, s67, s64
s_mov_b32 m0, s66
s_lshl_b32 s69, s67, 9
buffer_load_dwordx4 v64, s[8:11], s68 offen lds
v_mfma_f32_16x16x32_bf16 v[212:215], v[76:79], v[108:111], v[212:215]
s_add_u32 s74, s74, s72
s_lshl_b32 s75, s2, 2
v_mfma_f32_16x16x32_bf16 v[96:99], v[124:127], v[76:79], v[96:99]
buffer_load_dwordx4 v65, s[8:11], s68 offen offset:1024 lds
v_mfma_f32_16x16x32_bf16 v[100:103], v[128:131], v[76:79], v[100:103]
s_lshl_b32 s72, s78, 1
s_add_u32 s75, s75, s72
v_mfma_f32_16x16x32_bf16 v[80:83], v[124:127], v[108:111], v[80:83]
s_add_u32 m0, s66, 65536
s_add_u32 s69, s69, s65
buffer_load_dwordx4 v66, s[20:23], s69 offen lds
v_mfma_f32_16x16x32_bf16 v[84:87], v[128:131], v[108:111], v[84:87]
v_and_b32 v13, 31, v0
v_lshlrev_b32 v13, 10, v13
v_mfma_f32_16x16x32_bf16 v[88:91], v[124:127], v[112:115], v[88:91]
buffer_load_dwordx4 v67, s[20:23], s69 offen offset:1024 lds
s_add_u32 s66, s66, 8192
s_add_u32 s67, s67, 128
s_and_b32 s67, s67, 0x380
v_mfma_f32_16x16x32_bf16 v[92:95], v[128:131], v[112:115], v[92:95]
s_and_b32 s76, s5, 3
s_lshl_b32 s76, s76, 2
s_waitcnt vmcnt(8)
s_barrier
v_mfma_f32_16x16x32_bf16 v[216:219], v[116:119], v[116:119], v[216:219]
ds_read_b128 v[180:183], v68 offset:24576
ds_read_b128 v[184:187], v70 offset:24576
v_mfma_f32_16x16x32_bf16 v[212:215], v[76:79], v[116:119], v[212:215]
ds_read_b64_tr_b16 v[196:197], v72 offset:24576
ds_read_b64_tr_b16 v[198:199], v72 offset:25088
v_mfma_f32_16x16x32_bf16 v[96:99], v[132:135], v[76:79], v[96:99]
ds_read_b64_tr_b16 v[200:201], v73 offset:24576
ds_read_b64_tr_b16 v[202:203], v73 offset:25088
v_mfma_f32_16x16x32_bf16 v[100:103], v[136:139], v[76:79], v[100:103]
ds_read_b128 v[188:191], v69 offset:24576
ds_read_b128 v[192:195], v71 offset:24576
v_mfma_f32_16x16x32_bf16 v[80:83], v[132:135], v[116:119], v[80:83]
ds_read_b64_tr_b16 v[204:205], v72 offset:28672
ds_read_b64_tr_b16 v[206:207], v72 offset:29184
v_mfma_f32_16x16x32_bf16 v[84:87], v[136:139], v[116:119], v[84:87]
ds_read_b64_tr_b16 v[208:209], v73 offset:28672
ds_read_b64_tr_b16 v[210:211], v73 offset:29184
v_mfma_f32_16x16x32_bf16 v[88:91], v[132:135], v[120:123], v[88:91]
s_add_u32 s76, s76, s4
s_lshl_b32 s76, s76, 15
v_mfma_f32_16x16x32_bf16 v[92:95], v[136:139], v[120:123], v[92:95]
s_lshl_b32 s72, s6, 7
s_add_u32 s76, s76, s72
s_waitcnt lgkmcnt(0)
v_mfma_f32_16x16x32_bf16 v[216:219], v[180:183], v[180:183], v[216:219]
s_add_u32 s68, s67, s64
s_mov_b32 m0, s66
s_lshl_b32 s69, s67, 9
buffer_load_dwordx4 v64, s[8:11], s68 offen lds
v_mfma_f32_16x16x32_bf16 v[212:215], v[76:79], v[180:183], v[212:215]
v_mul_u32_u24 v14, 4682, v58
v_lshrrev_b32 v14, 16, v14
v_mfma_f32_16x16x32_bf16 v[96:99], v[196:199], v[76:79], v[96:99]
buffer_load_dwordx4 v65, s[8:11], s68 offen offset:1024 lds
v_mfma_f32_16x16x32_bf16 v[100:103], v[200:203], v[76:79], v[100:103]
v_mul_u32_u24 v14, 1792, v14
v_lshl_add_u32 v14, v58, 7, v14
v_mfma_f32_16x16x32_bf16 v[80:83], v[196:199], v[180:183], v[80:83]
s_add_u32 m0, s66, 65536
s_add_u32 s69, s69, s65
buffer_load_dwordx4 v66, s[20:23], s69 offen lds
v_mfma_f32_16x16x32_bf16 v[84:87], v[200:203], v[180:183], v[84:87]
s_lshl_b32 s77, s3, 2
s_add_u32 s77, s77, s4
v_mfma_f32_16x16x32_bf16 v[88:91], v[196:199], v[184:187], v[88:91]
buffer_load_dwordx4 v67, s[20:23], s69 offen offset:1024 lds
s_add_u32 s66, s66, 8192
s_add_u32 s67, s67, 128
s_and_b32 s67, s67, 0x380
v_mfma_f32_16x16x32_bf16 v[92:95], v[200:203], v[184:187], v[92:95]
s_mul_i32 s77, s77, 7168
s_and_b32 s72, s7, 1
s_waitcnt vmcnt(8)
s_barrier
v_mfma_f32_16x16x32_bf16 v[216:219], v[188:191], v[188:191], v[216:219]
ds_read_b128 v[108:111], v68 offset:32768
ds_read_b128 v[112:115], v70 offset:32768
v_mfma_f32_16x16x32_bf16 v[212:215], v[76:79], v[188:191], v[212:215]
ds_read_b64_tr_b16 v[124:125], v72 offset:32768
ds_read_b64_tr_b16 v[126:127], v72 offset:33280
v_mfma_f32_16x16x32_bf16 v[96:99], v[204:207], v[76:79], v[96:99]
ds_read_b64_tr_b16 v[128:129], v73 offset:32768
ds_read_b64_tr_b16 v[130:131], v73 offset:33280
v_mfma_f32_16x16x32_bf16 v[100:103], v[208:211], v[76:79], v[100:103]
ds_read_b128 v[116:119], v69 offset:32768
ds_read_b128 v[120:123], v71 offset:32768
v_mfma_f32_16x16x32_bf16 v[80:83], v[204:207], v[188:191], v[80:83]
ds_read_b64_tr_b16 v[132:133], v72 offset:36864
ds_read_b64_tr_b16 v[134:135], v72 offset:37376
v_mfma_f32_16x16x32_bf16 v[84:87], v[208:211], v[188:191], v[84:87]
ds_read_b64_tr_b16 v[136:137], v73 offset:36864
ds_read_b64_tr_b16 v[138:139], v73 offset:37376
v_mfma_f32_16x16x32_bf16 v[88:91], v[204:207], v[192:195], v[88:91]
s_mul_i32 s72, s72, 1792
s_add_u32 s77, s77, s72
v_mfma_f32_16x16x32_bf16 v[92:95], v[208:211], v[192:195], v[92:95]
s_waitcnt lgkmcnt(0)
v_mfma_f32_16x16x32_bf16 v[216:219], v[108:111], v[108:111], v[216:219]
s_add_u32 s68, s67, s64
s_mov_b32 m0, s66
s_lshl_b32 s69, s67, 9
buffer_load_dwordx4 v64, s[8:11], s68 offen lds
v_mfma_f32_16x16x32_bf16 v[212:215], v[76:79], v[108:111], v[212:215]
v_mfma_f32_16x16x32_bf16 v[96:99], v[124:127], v[76:79], v[96:99]
buffer_load_dwordx4 v65, s[8:11], s68 offen offset:1024 lds
v_mfma_f32_16x16x32_bf16 v[100:103], v[128:131], v[76:79], v[100:103]
v_mfma_f32_16x16x32_bf16 v[80:83], v[124:127], v[108:111], v[80:83]
s_add_u32 m0, s66, 65536
s_add_u32 s69, s69, s65
buffer_load_dwordx4 v66, s[20:23], s69 offen lds
v_mfma_f32_16x16x32_bf16 v[84:87], v[128:131], v[108:111], v[84:87]
v_mfma_f32_16x16x32_bf16 v[88:91], v[124:127], v[112:115], v[88:91]
buffer_load_dwordx4 v67, s[20:23], s69 offen offset:1024 lds
s_add_u32 s66, s66, 8192
s_add_u32 s67, s67, 128
s_and_b32 s67, s67, 0x380
v_mfma_f32_16x16x32_bf16 v[92:95], v[128:131], v[112:115], v[92:95]
s_mov_b32 exec_hi, 0
buffer_load_dword v255, v13, s[24:27], s76 offen
s_mov_b32 exec_hi, -1
s_waitcnt vmcnt(9)
s_barrier
v_mfma_f32_16x16x32_bf16 v[216:219], v[116:119], v[116:119], v[216:219]
ds_read_b128 v[180:183], v68 offset:40960
ds_read_b128 v[184:187], v70 offset:40960
v_mfma_f32_16x16x32_bf16 v[212:215], v[76:79], v[116:119], v[212:215]
ds_read_b64_tr_b16 v[196:197], v72 offset:40960
ds_read_b64_tr_b16 v[198:199], v72 offset:41472
v_mfma_f32_16x16x32_bf16 v[96:99], v[132:135], v[76:79], v[96:99]
ds_read_b64_tr_b16 v[200:201], v73 offset:40960
ds_read_b64_tr_b16 v[202:203], v73 offset:41472
v_mfma_f32_16x16x32_bf16 v[100:103], v[136:139], v[76:79], v[100:103]
ds_read_b128 v[188:191], v69 offset:40960
ds_read_b128 v[192:195], v71 offset:40960
v_mfma_f32_16x16x32_bf16 v[80:83], v[132:135], v[116:119], v[80:83]
ds_read_b64_tr_b16 v[204:205], v72 offset:45056
ds_read_b64_tr_b16 v[206:207], v72 offset:45568
v_mfma_f32_16x16x32_bf16 v[84:87], v[136:139], v[116:119], v[84:87]
ds_read_b64_tr_b16 v[208:209], v73 offset:45056
ds_read_b64_tr_b16 v[210:211], v73 offset:45568
v_mfma_f32_16x16x32_bf16 v[88:91], v[132:135], v[120:123], v[88:91]
v_mfma_f32_16x16x32_bf16 v[92:95], v[136:139], v[120:123], v[92:95]
s_waitcnt lgkmcnt(0)
v_mfma_f32_16x16x32_bf16 v[216:219], v[180:183], v[180:183], v[216:219]
s_add_u32 m0, s63, 132096
s_nop 0
buffer_load_dwordx4 v5, s[12:15], s70 offen lds
v_mfma_f32_16x16x32_bf16 v[212:215], v[76:79], v[180:183], v[212:215]
v_mfma_f32_16x16x32_bf16 v[96:99], v[196:199], v[76:79], v[96:99]
s_add_u32 m0, s63, 140288
s_nop 0
buffer_load_dwordx4 v4, s[16:19], s70 offen lds
v_mfma_f32_16x16x32_bf16 v[100:103], v[200:203], v[76:79], v[100:103]
v_mfma_f32_16x16x32_bf16 v[80:83], v[196:199], v[180:183], v[80:83]
s_add_u32 m0, s63, 133120
s_nop 0
buffer_load_dwordx4 v6, s[12:15], s71 offen lds
v_mfma_f32_16x16x32_bf16 v[84:87], v[200:203], v[180:183], v[84:87]
v_mfma_f32_16x16x32_bf16 v[88:91], v[196:199], v[184:187], v[88:91]
s_add_u32 m0, s63, 141312
s_nop 0
buffer_load_dwordx4 v5, s[16:19], s71 offen lds
v_mfma_f32_16x16x32_bf16 v[92:95], v[200:203], v[184:187], v[92:95]
s_waitcnt vmcnt(9)
s_barrier
v_mfma_f32_16x16x32_bf16 v[216:219], v[188:191], v[188:191], v[216:219]
ds_read_b128 v[108:111], v68 offset:49152
ds_read_b128 v[112:115], v70 offset:49152
v_mfma_f32_16x16x32_bf16 v[212:215], v[76:79], v[188:191], v[212:215]
ds_read_b64_tr_b16 v[124:125], v72 offset:49152
ds_read_b64_tr_b16 v[126:127], v72 offset:49664
v_mfma_f32_16x16x32_bf16 v[96:99], v[204:207], v[76:79], v[96:99]
ds_read_b64_tr_b16 v[128:129], v73 offset:49152
ds_read_b64_tr_b16 v[130:131], v73 offset:49664
v_mfma_f32_16x16x32_bf16 v[100:103], v[208:211], v[76:79], v[100:103]
ds_read_b128 v[116:119], v69 offset:49152
ds_read_b128 v[120:123], v71 offset:49152
v_mfma_f32_16x16x32_bf16 v[80:83], v[204:207], v[188:191], v[80:83]
ds_read_b64_tr_b16 v[132:133], v72 offset:53248
ds_read_b64_tr_b16 v[134:135], v72 offset:53760
v_mfma_f32_16x16x32_bf16 v[84:87], v[208:211], v[188:191], v[84:87]
ds_read_b64_tr_b16 v[136:137], v73 offset:53248
ds_read_b64_tr_b16 v[138:139], v73 offset:53760
v_mfma_f32_16x16x32_bf16 v[88:91], v[204:207], v[192:195], v[88:91]
v_mfma_f32_16x16x32_bf16 v[92:95], v[208:211], v[192:195], v[92:95]
s_waitcnt lgkmcnt(0)
v_mfma_f32_16x16x32_bf16 v[216:219], v[108:111], v[108:111], v[216:219]
s_mov_b32 m0, 131072
s_nop 0
buffer_load_dwordx4 v7, s[12:15], s73 offen lds
v_mfma_f32_16x16x32_bf16 v[212:215], v[76:79], v[108:111], v[212:215]
v_mfma_f32_16x16x32_bf16 v[96:99], v[124:127], v[76:79], v[96:99]
buffer_load_dwordx4 v[140:143], v3, s[52:55], s74 offen
v_mfma_f32_16x16x32_bf16 v[100:103], v[128:131], v[76:79], v[100:103]
v_mfma_f32_16x16x32_bf16 v[80:83], v[124:127], v[108:111], v[80:83]
buffer_load_dword v144, v62, s[48:51], 0 offen sc1
v_mfma_f32_16x16x32_bf16 v[84:87], v[128:131], v[108:111], v[84:87]
v_mfma_f32_16x16x32_bf16 v[88:91], v[124:127], v[112:115], v[88:91]
buffer_load_ushort v63, v62, s[56:59], s75 offen
v_mfma_f32_16x16x32_bf16 v[92:95], v[128:131], v[112:115], v[92:95]
s_add_u32 s72, s77, 0
s_mov_b32 exec_lo, 0xfffffff
s_mov_b32 exec_hi, 0
buffer_load_dword v254, v14, s[28:31], s72 offen
s_mov_b64 exec, -1
s_waitcnt vmcnt(10)
s_barrier
v_mfma_f32_16x16x32_bf16 v[216:219], v[116:119], v[116:119], v[216:219]
ds_read_b128 v[180:183], v68 offset:57344
ds_read_b128 v[184:187], v70 offset:57344
v_mfma_f32_16x16x32_bf16 v[212:215], v[76:79], v[116:119], v[212:215]
ds_read_b64_tr_b16 v[196:197], v72 offset:57344
ds_read_b64_tr_b16 v[198:199], v72 offset:57856
v_mfma_f32_16x16x32_bf16 v[96:99], v[132:135], v[76:79], v[96:99]
ds_read_b64_tr_b16 v[200:201], v73 offset:57344
ds_read_b64_tr_b16 v[202:203], v73 offset:57856
v_mfma_f32_16x16x32_bf16 v[100:103], v[136:139], v[76:79], v[100:103]
ds_read_b128 v[188:191], v69 offset:57344
ds_read_b128 v[192:195], v71 offset:57344
v_mfma_f32_16x16x32_bf16 v[80:83], v[132:135], v[116:119], v[80:83]
ds_read_b64_tr_b16 v[204:205], v72 offset:61440
ds_read_b64_tr_b16 v[206:207], v72 offset:61952
v_mfma_f32_16x16x32_bf16 v[84:87], v[136:139], v[116:119], v[84:87]
ds_read_b64_tr_b16 v[208:209], v73 offset:61440
ds_read_b64_tr_b16 v[210:211], v73 offset:61952
v_mfma_f32_16x16x32_bf16 v[88:91], v[132:135], v[120:123], v[88:91]
v_mfma_f32_16x16x32_bf16 v[92:95], v[136:139], v[120:123], v[92:95]
s_waitcnt lgkmcnt(0)
v_mfma_f32_16x16x32_bf16 v[216:219], v[180:183], v[180:183], v[216:219]
v_mfma_f32_16x16x32_bf16 v[212:215], v[76:79], v[180:183], v[212:215]
v_mfma_f32_16x16x32_bf16 v[96:99], v[196:199], v[76:79], v[96:99]
v_mfma_f32_16x16x32_bf16 v[100:103], v[200:203], v[76:79], v[100:103]
v_mfma_f32_16x16x32_bf16 v[80:83], v[196:199], v[180:183], v[80:83]
v_mfma_f32_16x16x32_bf16 v[84:87], v[200:203], v[180:183], v[84:87]
v_mfma_f32_16x16x32_bf16 v[88:91], v[196:199], v[184:187], v[88:91]
v_mfma_f32_16x16x32_bf16 v[92:95], v[200:203], v[184:187], v[92:95]
v_mfma_f32_16x16x32_bf16 v[216:219], v[188:191], v[188:191], v[216:219]
v_mfma_f32_16x16x32_bf16 v[212:215], v[76:79], v[188:191], v[212:215]
v_mfma_f32_16x16x32_bf16 v[96:99], v[204:207], v[76:79], v[96:99]
v_mfma_f32_16x16x32_bf16 v[100:103], v[208:211], v[76:79], v[100:103]
v_mfma_f32_16x16x32_bf16 v[80:83], v[204:207], v[188:191], v[80:83]
v_mfma_f32_16x16x32_bf16 v[84:87], v[208:211], v[188:191], v[84:87]
v_mfma_f32_16x16x32_bf16 v[88:91], v[204:207], v[192:195], v[88:91]
v_mfma_f32_16x16x32_bf16 v[92:95], v[208:211], v[192:195], v[92:95]
v_and_b32 v7, 1, v60
s_sub_u32 s63, s65, s67
s_and_b32 s63, s63, 0x380
v_cmp_eq_u32 vcc, 1, v7
s_lshl_b32 s63, s63, 6
s_lshl_b32 s3, s4, 11
v_cmp_eq_u32 s[74:75], v59, v57
s_add_u32 s63, s63, s3
v_lshrrev_b32 v3, 1, v56
v_cndmask_b32 v216, v216, v217, vcc
v_lshrrev_b32 v4, 1, v57
v_xor_b32 v3, v3, v4
v_cndmask_b32 v218, v218, v219, vcc
v_lshlrev_b32 v3, 4, v3
v_and_b32 v4, 1, v57
v_cmp_lt_u32 vcc, 1, v60
v_lshl_or_b32 v3, v4, 3, v3
v_lshl_add_u32 v3, v56, 7, v3
v_mul_f32 v104, 0x3b000000, v212
v_add_u32 v3, s63, v3
s_lshl_b32 s63, s4, 7
v_mov_b32 v109, 0x3b000000
s_add_u32 s63, s63, 148480
v_lshlrev_b32 v2, 3, v56
v_cndmask_b32 v216, v216, v218, vcc
v_add_u32 v2, s63, v2
s_lshl_b32 s63, s6, 1
v_cndmask_b32 v105, 0, v216, s[74:75]
s_add_u32 s63, s63, s79
s_lshl_b32 s63, s63, 17
v_mov_b32 v108, v105
s_add_u32 s63, s63, 1048576
s_lshr_b32 s72, s6, 2
v_permlane32_swap_b32 v105, v108
s_add_u32 s72, s72, 1
s_sub_u32 s73, 0, s72
v_add_f32 v105, v105, v108
s_bitcmp1_b32 s6, 1
s_cselect_b32 s72, s73, s72
s_lshl_b32 s3, s5, 6
v_mov_b32 v108, v105
s_add_u32 s72, s72, s3
s_lshl_b32 s3, s4, 4
v_permlane16_swap_b32 v105, v108
v_add_u32 v5, s3, v56
v_xor_b32 v6, 16, v5
v_add_f32 v105, v105, v108
v_add_u32 v5, s72, v5
v_add_u32 v6, s72, v6
v_mul_f32 v108, v104, v104
s_movk_i32 s72, 2048
v_cmp_gt_u32 s[70:71], s72, v5
v_fma_f32 v105, v105, v109, -v108
v_cmp_gt_u32 s[64:65], s72, v6
v_and_b32 v5, 2047, v5
v_max_f32 v105, 0, v105
v_and_b32 v6, 2047, v6
v_lshlrev_b32 v1, 15, v57
v_add_f32 v108, 0x3727c5ac, v105
v_lshl_add_u32 v5, v5, 4, v1
v_lshl_add_u32 v6, v6, 4, v1
v_rsq_f32 v110, v108
v_rcp_f32 v108, v108
v_mov_b32 v109, 0x3727c5ac
v_fma_f32 v108, v105, v108, v109
v_rsq_f32 v108, v108
s_nop 0
v_mul_f32 v105, v108, v110
ds_write_b64 v2, v[104:105]
v_xor_b32 v4, 0, v3
ds_read_b64 v[124:125], v4
v_xor_b32 v4, 32, v3
ds_read_b64 v[126:127], v4
v_xor_b32 v4, 64, v3
ds_read_b64 v[128:129], v4
v_xor_b32 v4, 96, v3
ds_read_b64 v[130:131], v4
v_xor_b32 v2, 128, v2
v_rcp_f32 v122, v105
v_sub_f32 v116, 0, v104
v_mul_f32 v118, 0xc0135761, v105
v_mul_f32 v120, v105, v105
v_mov_b32 v117, v116
v_mul_f32 v120, v120, v118
v_mov_b32 v119, v118
v_mov_b32 v123, v122
v_mul_f32 v120, 0x3d372713, v120
v_mov_b32 v121, v120
v_pk_fma_f32 v[156:157], v[96:97], v[116:117], v[80:81]
v_pk_fma_f32 v[160:161], v[98:99], v[116:117], v[82:83]
v_pk_fma_f32 v[164:165], v[100:101], v[116:117], v[84:85]
v_pk_fma_f32 v[168:169], v[102:103], v[116:117], v[86:87]
v_pk_mul_f32 v[158:159], v[156:157], v[156:157]
v_pk_mul_f32 v[162:163], v[160:161], v[160:161]
v_pk_mul_f32 v[166:167], v[164:165], v[164:165]
v_pk_mul_f32 v[170:171], v[168:169], v[168:169]
v_pk_fma_f32 v[158:159], v[158:159], v[120:121], v[118:119]
v_pk_fma_f32 v[162:163], v[162:163], v[120:121], v[118:119]
v_pk_fma_f32 v[166:167], v[166:167], v[120:121], v[118:119]
v_pk_fma_f32 v[170:171], v[170:171], v[120:121], v[118:119]
v_pk_mul_f32 v[158:159], v[158:159], v[156:157]
v_pk_mul_f32 v[162:163], v[162:163], v[160:161]
v_pk_mul_f32 v[166:167], v[166:167], v[164:165]
v_pk_mul_f32 v[170:171], v[170:171], v[168:169]
v_exp_f32 v158, v158
v_exp_f32 v159, v159
v_exp_f32 v162, v162
v_exp_f32 v163, v163
v_exp_f32 v166, v166
v_exp_f32 v167, v167
v_exp_f32 v170, v170
v_exp_f32 v171, v171
v_pk_fma_f32 v[158:159], v[158:159], v[122:123], v[122:123]
v_pk_fma_f32 v[162:163], v[162:163], v[122:123], v[122:123]
v_pk_fma_f32 v[166:167], v[166:167], v[122:123], v[122:123]
v_pk_fma_f32 v[170:171], v[170:171], v[122:123], v[122:123]
v_rcp_f32 v158, v158
v_rcp_f32 v159, v159
v_rcp_f32 v162, v162
v_rcp_f32 v163, v163
v_rcp_f32 v166, v166
v_rcp_f32 v167, v167
v_rcp_f32 v170, v170
v_rcp_f32 v171, v171
v_pk_mul_f32 v[156:157], v[156:157], v[158:159]
v_pk_mul_f32 v[160:161], v[160:161], v[162:163]
v_pk_mul_f32 v[164:165], v[164:165], v[166:167]
v_pk_mul_f32 v[168:169], v[168:169], v[170:171]
v_cvt_pk_bf16_f32 v148, v156, v157
v_cvt_pk_bf16_f32 v149, v160, v161
v_cvt_pk_bf16_f32 v150, v164, v165
v_cvt_pk_bf16_f32 v151, v168, v169
v_cndmask_b32 v148, 0, v148, s[70:71]
v_cndmask_b32 v149, 0, v149, s[70:71]
v_cndmask_b32 v150, 0, v150, s[70:71]
v_cndmask_b32 v151, 0, v151, s[70:71]
buffer_store_dwordx4 v[148:151], v5, s[44:47], s63 offen sc1
s_waitcnt lgkmcnt(0)
s_barrier
ds_read_b64 v[112:113], v2
s_waitcnt lgkmcnt(0)
v_rcp_f32 v138, v113
v_sub_f32 v132, 0, v112
v_mul_f32 v134, 0xc0135761, v113
v_mul_f32 v136, v113, v113
v_mov_b32 v133, v132
v_mul_f32 v136, v136, v134
v_mov_b32 v135, v134
v_mov_b32 v139, v138
v_mul_f32 v136, 0x3d372713, v136
v_mov_b32 v137, v136
v_pk_fma_f32 v[156:157], v[96:97], v[132:133], v[88:89]
v_pk_fma_f32 v[160:161], v[98:99], v[132:133], v[90:91]
v_pk_fma_f32 v[164:165], v[100:101], v[132:133], v[92:93]
v_pk_fma_f32 v[168:169], v[102:103], v[132:133], v[94:95]
v_pk_mul_f32 v[158:159], v[156:157], v[156:157]
v_pk_mul_f32 v[162:163], v[160:161], v[160:161]
v_pk_mul_f32 v[166:167], v[164:165], v[164:165]
v_pk_mul_f32 v[170:171], v[168:169], v[168:169]
v_pk_fma_f32 v[158:159], v[158:159], v[136:137], v[134:135]
v_pk_fma_f32 v[162:163], v[162:163], v[136:137], v[134:135]
v_pk_fma_f32 v[166:167], v[166:167], v[136:137], v[134:135]
v_pk_fma_f32 v[170:171], v[170:171], v[136:137], v[134:135]
v_pk_mul_f32 v[158:159], v[158:159], v[156:157]
v_pk_mul_f32 v[162:163], v[162:163], v[160:161]
v_pk_mul_f32 v[166:167], v[166:167], v[164:165]
v_pk_mul_f32 v[170:171], v[170:171], v[168:169]
v_exp_f32 v158, v158
v_exp_f32 v159, v159
v_exp_f32 v162, v162
v_exp_f32 v163, v163
v_exp_f32 v166, v166
v_exp_f32 v167, v167
v_exp_f32 v170, v170
v_exp_f32 v171, v171
v_pk_fma_f32 v[158:159], v[158:159], v[138:139], v[138:139]
v_pk_fma_f32 v[162:163], v[162:163], v[138:139], v[138:139]
v_pk_fma_f32 v[166:167], v[166:167], v[138:139], v[138:139]
v_pk_fma_f32 v[170:171], v[170:171], v[138:139], v[138:139]
v_rcp_f32 v158, v158
v_rcp_f32 v159, v159
v_rcp_f32 v162, v162
v_rcp_f32 v163, v163
v_rcp_f32 v166, v166
v_rcp_f32 v167, v167
v_rcp_f32 v170, v170
v_rcp_f32 v171, v171
v_pk_mul_f32 v[156:157], v[156:157], v[158:159]
v_pk_mul_f32 v[160:161], v[160:161], v[162:163]
v_pk_mul_f32 v[164:165], v[164:165], v[166:167]
v_pk_mul_f32 v[168:169], v[168:169], v[170:171]
v_cvt_pk_bf16_f32 v152, v156, v157
v_cvt_pk_bf16_f32 v153, v160, v161
v_cvt_pk_bf16_f32 v154, v164, v165
v_cvt_pk_bf16_f32 v155, v168, v169
v_cndmask_b32 v152, 0, v152, s[64:65]
v_cndmask_b32 v153, 0, v153, s[64:65]
v_cndmask_b32 v154, 0, v154, s[64:65]
v_cndmask_b32 v155, 0, v155, s[64:65]
buffer_store_dwordx4 v[152:155], v6, s[44:47], s63 offen sc1
v_lshrrev_b32 v1, 3, v58
v_and_b32 v2, 7, v0
v_and_b32 v3, 6, v1
v_xor_b32 v3, v2, v3
v_lshlrev_b32 v4, 10, v1
v_lshl_add_u32 v8, v3, 4, v4
s_lshl_b32 s71, s4, 12
s_lshl_b32 s70, s4, 15
s_lshl_b32 s3, s6, 7
s_add_u32 s70, s70, s3
v_add_u32 v9, 7168, v8
v_add_u32 v10, 14336, v8
v_add_u32 v11, 21504, v8
v_lshlrev_b32 v16, 16, v124
s_add_u32 s72, s70, 0
s_add_u32 m0, s71, 65536
v_and_b32 v17, 0xffff0000, v124
v_lshlrev_b32 v18, 16, v125
v_and_b32 v19, 0xffff0000, v125
v_lshlrev_b32 v20, 16, v126
v_and_b32 v21, 0xffff0000, v126
v_lshlrev_b32 v22, 16, v127
v_and_b32 v23, 0xffff0000, v127
v_lshlrev_b32 v24, 16, v128
buffer_load_dwordx4 v8, s[24:27], s72 offen offset:0 lds
v_and_b32 v25, 0xffff0000, v128
v_lshlrev_b32 v26, 16, v129
v_and_b32 v27, 0xffff0000, v129
v_lshlrev_b32 v28, 16, v130
v_and_b32 v29, 0xffff0000, v130
v_lshlrev_b32 v30, 16, v131
v_and_b32 v31, 0xffff0000, v131
v_sub_f32 v104, 0, v104
buffer_load_dwordx4 v9, s[24:27], s72 offen offset:1024 lds
v_mov_b32 v105, v104
v_mov_b32 v111, v110
v_pk_add_f32 v[32:33], v[16:17], v[104:105]
v_pk_add_f32 v[34:35], v[18:19], v[104:105]
v_pk_add_f32 v[36:37], v[20:21], v[104:105]
v_pk_add_f32 v[38:39], v[22:23], v[104:105]
v_pk_add_f32 v[40:41], v[24:25], v[104:105]
v_pk_add_f32 v[42:43], v[26:27], v[104:105]
buffer_load_dwordx4 v10, s[24:27], s72 offen offset:2048 lds
v_pk_add_f32 v[44:45], v[28:29], v[104:105]
v_pk_add_f32 v[46:47], v[30:31], v[104:105]
v_pk_mul_f32 v[32:33], v[32:33], v[110:111]
v_pk_mul_f32 v[34:35], v[34:35], v[110:111]
v_pk_mul_f32 v[36:37], v[36:37], v[110:111]
v_pk_mul_f32 v[38:39], v[38:39], v[110:111]
v_pk_mul_f32 v[40:41], v[40:41], v[110:111]
v_pk_mul_f32 v[42:43], v[42:43], v[110:111]
buffer_load_dwordx4 v11, s[24:27], s72 offen offset:3072 lds
v_pk_mul_f32 v[44:45], v[44:45], v[110:111]
v_pk_mul_f32 v[46:47], v[46:47], v[110:111]
v_lshrrev_b32 v3, 2, v1
s_lshl_b32 s3, s4, 1
v_add_u32 v3, s3, v3
v_and_b32 v4, 3, v1
v_lshlrev_b32 v4, 2, v4
v_lshl_add_u32 v6, v2, 10, v4
s_add_u32 s72, s70, 131072
s_add_u32 m0, s71, 81920
v_add_u32 v6, 131072, v6
v_xor_b32 v4, v3, v2
v_lshl_add_u32 v4, v4, 4, v6
v_add_u32 v5, 1, v2
v_and_b32 v5, 7, v5
v_xor_b32 v5, v3, v5
v_lshl_add_u32 v5, v5, 4, v6
v_lshlrev_b32 v1, 13, v1
buffer_load_dwordx4 v8, s[24:27], s72 offen offset:0 lds
v_lshl_add_u32 v2, v2, 4, v1
v_add_u32 v3, 4096, v2
s_lshl_b32 s63, s6, 18
s_lshl_b32 s3, s4, 16
s_add_u32 s63, s63, s3
s_lshl_b32 s3, s5, 7
s_add_u32 s63, s63, s3
s_add_u32 s63, s63, 13631488
buffer_load_dwordx4 v9, s[24:27], s72 offen offset:1024 lds
s_mul_i32 s68, s4, 114688
s_mul_i32 s3, s61, 224
s_add_u32 s68, s68, s3
s_mul_i32 s69, s4, 7168
v_lshlrev_b32 v12, 4, v58
s_lshl_b32 s73, s5, 7
s_add_u32 s73, s73, 0
v_add_u32 v7, 0, v58
buffer_load_dwordx4 v10, s[24:27], s72 offen offset:2048 lds
v_mul_u32_u24 v244, 4682, v7
v_lshrrev_b32 v244, 16, v244
v_mul_u32_u24 v244, 3360, v244
v_lshl_add_u32 v244, v7, 4, v244
v_add_u32 v7, 64, v58
v_mul_u32_u24 v245, 4682, v7
v_lshrrev_b32 v245, 16, v245
v_mul_u32_u24 v245, 3360, v245
buffer_load_dwordx4 v11, s[24:27], s72 offen offset:3072 lds
v_lshl_add_u32 v245, v7, 4, v245
v_subrev_u32 v245, 1024, v245
v_add_u32 v7, 128, v58
v_mul_u32_u24 v246, 4682, v7
v_lshrrev_b32 v246, 16, v246
v_mul_u32_u24 v246, 3360, v246
v_lshl_add_u32 v246, v7, 4, v246
v_subrev_u32 v246, 2048, v246
s_add_u32 s72, s70, 262144
s_add_u32 m0, s71, 98304
v_add_u32 v7, 192, v58
v_mul_u32_u24 v247, 4682, v7
v_lshrrev_b32 v247, 16, v247
v_mul_u32_u24 v247, 3360, v247
v_lshl_add_u32 v247, v7, 4, v247
v_subrev_u32 v247, 3072, v247
v_add_u32 v7, 256, v58
v_mul_u32_u24 v248, 4682, v7
buffer_load_dwordx4 v8, s[24:27], s72 offen offset:0 lds
v_lshrrev_b32 v248, 16, v248
v_mul_u32_u24 v248, 3360, v248
v_lshl_add_u32 v248, v7, 4, v248
v_add_u32 v7, 320, v58
v_mul_u32_u24 v249, 4682, v7
v_lshrrev_b32 v249, 16, v249
v_mul_u32_u24 v249, 3360, v249
v_lshl_add_u32 v249, v7, 4, v249
v_subrev_u32 v249, 1024, v249
v_add_u32 v7, 384, v58
v_mul_u32_u24 v250, 4682, v7
v_lshrrev_b32 v250, 16, v250
v_mul_u32_u24 v250, 3360, v250
v_lshl_add_u32 v250, v7, 4, v250
v_subrev_u32 v250, 2048, v250
s_waitcnt vmcnt(13)
v_readfirstlane_b32 s3, v144
s_cmp_lg_u32 s3, 0
s_cbranch_scc1 L_ini_2
s_mov_b64 exec, 1
s_mov_b32 s3, 0
L_poll_3:
buffer_load_dword v255, v62, s[48:51], 0 offen sc1
s_add_u32 s3, s3, 1
s_cmp_gt_u32 s3, 400000
s_cbranch_scc1 L_pollx_4
s_waitcnt vmcnt(0)
v_cmp_gt_u32 vcc, 1, v255
s_cbranch_vccnz L_poll_3
L_pollx_4:
s_waitcnt vmcnt(0)
s_mov_b64 exec, -1
L_ini_2:
s_waitcnt vmcnt(9)
s_barrier
s_cmp_lg_u32 s4, 0
s_cbranch_scc1 L_sig_5
s_mov_b64 exec, 1
v_mov_b32 v255, 1
buffer_atomic_add v255, v62, s[44:47], s73 offen sc1
s_mov_b64 exec, -1
L_sig_5:
ds_read_b32 v172, v4 offset:640
ds_read_b32 v173, v4 offset:768
ds_read_b32 v174, v4 offset:896
ds_read_b32 v175, v5 offset:1024
ds_read_b32 v176, v5 offset:1152
ds_read_b32 v177, v5 offset:1280
ds_read_b32 v178, v5 offset:1408
ds_read_b32 v179, v5 offset:1536
ds_read_b32 v180, v5 offset:1664
ds_read_b32 v181, v5 offset:1792
ds_read_b32 v182, v5 offset:1920
ds_read_b32 v184, v4 offset:9216
ds_read_b32 v185, v4 offset:9344
ds_read_b32 v186, v4 offset:9472
ds_read_b32 v187, v4 offset:9600
ds_read_b32 v188, v4 offset:9728
ds_read_b32 v189, v4 offset:9856
ds_read_b32 v190, v4 offset:9984
ds_read_b32 v191, v4 offset:10112
v_lshlrev_b32 v192, 16, v140
buffer_load_dwordx4 v9, s[24:27], s72 offen offset:1024 lds
v_lshlrev_b32 v193, 16, v142
v_and_b32 v194, 0xffff0000, v140
v_and_b32 v195, 0xffff0000, v142
v_lshlrev_b32 v196, 16, v141
v_lshlrev_b32 v197, 16, v143
buffer_load_dwordx4 v10, s[24:27], s72 offen offset:2048 lds
v_and_b32 v198, 0xffff0000, v141
v_and_b32 v199, 0xffff0000, v143
s_waitcnt lgkmcnt(8)
v_lshlrev_b32 v200, 16, v172
v_and_b32 v201, 0xffff0000, v172
buffer_load_dwordx4 v11, s[24:27], s72 offen offset:3072 lds
v_lshlrev_b32 v202, 16, v173
v_and_b32 v203, 0xffff0000, v173
v_lshlrev_b32 v204, 16, v174
v_and_b32 v205, 0xffff0000, v174
v_lshlrev_b32 v206, 16, v175
s_add_u32 s72, s70, 393216
s_add_u32 m0, s71, 114688
v_and_b32 v207, 0xffff0000, v175
v_lshlrev_b32 v208, 16, v176
v_and_b32 v209, 0xffff0000, v176
v_lshlrev_b32 v210, 16, v177
v_and_b32 v211, 0xffff0000, v177
buffer_load_dwordx4 v8, s[24:27], s72 offen offset:0 lds
v_lshlrev_b32 v212, 16, v178
v_and_b32 v213, 0xffff0000, v178
v_lshlrev_b32 v214, 16, v179
v_and_b32 v215, 0xffff0000, v179
v_lshlrev_b32 v216, 16, v180
buffer_load_dwordx4 v9, s[24:27], s72 offen offset:1024 lds
v_and_b32 v217, 0xffff0000, v180
v_lshlrev_b32 v218, 16, v181
v_and_b32 v219, 0xffff0000, v181
v_lshlrev_b32 v220, 16, v182
v_and_b32 v221, 0xffff0000, v182
buffer_load_dwordx4 v10, s[24:27], s72 offen offset:2048 lds
v_pk_mul_f32 v[222:223], v[200:201], v[198:199]
v_pk_mul_f32 v[224:225], v[202:203], v[198:199]
v_pk_mul_f32 v[226:227], v[204:205], v[198:199]
v_pk_mul_f32 v[228:229], v[206:207], v[198:199]
v_pk_mul_f32 v[230:231], v[208:209], v[198:199]
buffer_load_dwordx4 v11, s[24:27], s72 offen offset:3072 lds
v_pk_mul_f32 v[232:233], v[210:211], v[198:199]
v_pk_mul_f32 v[234:235], v[212:213], v[198:199]
v_pk_mul_f32 v[236:237], v[214:215], v[198:199]
v_pk_fma_f32 v[222:223], v[202:203], v[196:197], v[222:223]
v_pk_fma_f32 v[224:225], v[204:205], v[196:197], v[224:225]
s_add_u32 s72, s68, 0
s_add_u32 m0, s69, 0
v_pk_fma_f32 v[226:227], v[206:207], v[196:197], v[226:227]
v_pk_fma_f32 v[228:229], v[208:209], v[196:197], v[228:229]
v_pk_fma_f32 v[230:231], v[210:211], v[196:197], v[230:231]
v_pk_fma_f32 v[232:233], v[212:213], v[196:197], v[232:233]
v_pk_fma_f32 v[234:235], v[214:215], v[196:197], v[234:235]
buffer_load_dwordx4 v244, s[28:31], s72 offen offset:0 lds
v_pk_fma_f32 v[236:237], v[216:217], v[196:197], v[236:237]
v_pk_fma_f32 v[222:223], v[204:205], v[194:195], v[222:223]
v_pk_fma_f32 v[224:225], v[206:207], v[194:195], v[224:225]
v_pk_fma_f32 v[226:227], v[208:209], v[194:195], v[226:227]
v_pk_fma_f32 v[228:229], v[210:211], v[194:195], v[228:229]
buffer_load_dwordx4 v245, s[28:31], s72 offen offset:1024 lds
v_pk_fma_f32 v[230:231], v[212:213], v[194:195], v[230:231]
v_pk_fma_f32 v[232:233], v[214:215], v[194:195], v[232:233]
v_pk_fma_f32 v[234:235], v[216:217], v[194:195], v[234:235]
v_pk_fma_f32 v[236:237], v[218:219], v[194:195], v[236:237]
v_pk_fma_f32 v[222:223], v[206:207], v[192:193], v[222:223]
buffer_load_dwordx4 v246, s[28:31], s72 offen offset:2048 lds
v_pk_fma_f32 v[224:225], v[208:209], v[192:193], v[224:225]
v_pk_fma_f32 v[226:227], v[210:211], v[192:193], v[226:227]
v_pk_fma_f32 v[228:229], v[212:213], v[192:193], v[228:229]
v_pk_fma_f32 v[230:231], v[214:215], v[192:193], v[230:231]
v_pk_fma_f32 v[232:233], v[216:217], v[192:193], v[232:233]
buffer_load_dwordx4 v247, s[28:31], s72 offen offset:3072 lds
v_pk_fma_f32 v[234:235], v[218:219], v[192:193], v[234:235]
v_pk_fma_f32 v[236:237], v[220:221], v[192:193], v[236:237]
s_waitcnt lgkmcnt(0)
v_lshlrev_b32 v148, 16, v184
v_and_b32 v149, 0xffff0000, v184
s_add_u32 m0, s69, 4096
v_lshlrev_b32 v150, 16, v185
v_and_b32 v151, 0xffff0000, v185
v_lshlrev_b32 v152, 16, v186
v_and_b32 v153, 0xffff0000, v186
v_lshlrev_b32 v154, 16, v187
buffer_load_dwordx4 v248, s[28:31], s72 offen offset:0 lds
v_and_b32 v155, 0xffff0000, v187
v_lshlrev_b32 v156, 16, v188
v_and_b32 v157, 0xffff0000, v188
v_lshlrev_b32 v158, 16, v189
v_and_b32 v159, 0xffff0000, v189
buffer_load_dwordx4 v249, s[28:31], s72 offen offset:1024 lds
v_lshlrev_b32 v160, 16, v190
v_and_b32 v161, 0xffff0000, v190
v_lshlrev_b32 v162, 16, v191
v_and_b32 v163, 0xffff0000, v191
v_pk_mul_f32 v[222:223], v[222:223], v[148:149]
buffer_load_dwordx4 v250, s[28:31], s72 offen offset:2048 lds
v_pk_mul_f32 v[224:225], v[224:225], v[150:151]
v_pk_mul_f32 v[226:227], v[226:227], v[152:153]
v_pk_mul_f32 v[228:229], v[228:229], v[154:155]
v_pk_mul_f32 v[230:231], v[230:231], v[156:157]
v_pk_mul_f32 v[232:233], v[232:233], v[158:159]
s_add_u32 s72, s77, 917504
s_mov_b32 exec_lo, 0xfffffff
s_mov_b32 exec_hi, 0
buffer_load_dword v254, v14, s[28:31], s72 offen
s_mov_b64 exec, -1
v_pk_mul_f32 v[234:235], v[234:235], v[160:161]
v_pk_mul_f32 v[236:237], v[236:237], v[162:163]
v_cvt_pk_bf16_f32 v164, v222, v224
v_cvt_pk_bf16_f32 v165, v226, v228
v_cvt_pk_bf16_f32 v166, v230, v232
v_cvt_pk_bf16_f32 v167, v234, v236
v_cvt_pk_bf16_f32 v168, v223, v225
v_cvt_pk_bf16_f32 v169, v227, v229
v_cvt_pk_bf16_f32 v170, v231, v233
v_cvt_pk_bf16_f32 v171, v235, v237
buffer_store_dwordx4 v[164:167], v2, s[44:47], s63 offen sc1
buffer_store_dwordx4 v[168:171], v3, s[44:47], s63 offen sc1
v_lshl_add_u32 v1, v57, 2, v59
v_mul_u32_u24 v2, 224, v1
v_lshl_add_u32 v64, v60, 3, v2
v_add_u32 v65, 65536, v64
v_and_b32 v2, 6, v1
v_lshrrev_b32 v3, 1, v60
v_xor_b32 v2, v2, v3
v_lshlrev_b32 v2, 4, v2
v_and_b32 v3, 1, v60
v_lshl_or_b32 v2, v3, 3, v2
v_lshl_add_u32 v1, v1, 7, v2
v_add_u32 v66, 65536, v1
s_lshl_b32 s63, s5, 6
s_lshl_b32 s3, s4, 4
s_add_u32 s63, s63, s3
v_add_u32 v1, s63, v56
v_lshlrev_b32 v2, 15, v57
v_lshl_add_u32 v70, v1, 4, v2
v_add_u32 v5, s5, v58
v_add_u32 v5, 31, v5
v_and_b32 v5, 31, v5
v_lshlrev_b32 v5, 7, v5
s_mov_b32 s63, 1048576
s_lshr_b32 s66, s2, 5
s_lshl_b32 s66, s66, 10
s_add_u32 s66, s66, 16384
s_lshl_b32 s73, s6, 3
s_lshr_b32 s3, s5, 2
s_add_u32 s73, s73, s3
s_lshl_b32 s73, s73, 7
s_add_u32 s73, s73, 16384
v_lshlrev_b32 v252, 7, v58
v_xor_b32 v67, 32, v66
v_xor_b32 v68, 64, v66
v_xor_b32 v69, 96, v66
s_cmp_lg_u32 s4, 0
s_cbranch_scc1 L_wf_6
s_mov_b64 exec, 7
s_mov_b32 s3, 0
L_poll_7:
buffer_load_dword v255, v5, s[44:47], 0 offen sc1
s_add_u32 s3, s3, 1
s_cmp_gt_u32 s3, 400000
s_cbranch_scc1 L_pollx_8
s_waitcnt vmcnt(0)
v_cmp_gt_u32 vcc, 8, v255
s_cbranch_vccnz L_poll_7
L_pollx_8:
s_waitcnt vmcnt(0)
s_mov_b64 exec, -1
L_wf_6:
s_barrier
buffer_load_dwordx4 v[92:95], v70, s[44:47], s63 offen sc1
s_add_u32 s63, s63, 131072
buffer_load_dwordx4 v[96:99], v70, s[44:47], s63 offen sc1
s_add_u32 s63, s63, 131072
buffer_load_dwordx4 v[100:103], v70, s[44:47], s63 offen sc1
s_add_u32 s63, s63, 131072
buffer_load_dwordx4 v[104:107], v70, s[44:47], s63 offen sc1
s_add_u32 s63, s63, 131072
buffer_load_dwordx4 v[108:111], v70, s[44:47], s63 offen sc1
s_add_u32 s63, s63, 131072
buffer_load_dwordx4 v[112:115], v70, s[44:47], s63 offen sc1
s_add_u32 s63, s63, 131072
buffer_load_dwordx4 v[116:119], v70, s[44:47], s63 offen sc1
s_add_u32 s63, s63, 131072
buffer_load_dwordx4 v[120:123], v70, s[44:47], s63 offen sc1
s_add_u32 s63, s63, 131072
buffer_load_dwordx4 v[124:127], v70, s[44:47], s63 offen sc1
s_add_u32 s63, s63, 131072
buffer_load_dwordx4 v[128:131], v70, s[44:47], s63 offen sc1
s_add_u32 s63, s63, 131072
s_waitcnt vmcnt(10)
s_barrier
s_cmp_lg_u32 s4, 0
s_cbranch_scc1 L_sig_9
s_mov_b64 exec, 1
v_mov_b32 v255, 1
buffer_atomic_add v255, v62, s[44:47], s73 offen sc1
s_mov_b64 exec, -1
L_sig_9:
ds_read_b64_tr_b16 v[156:157], v66 offset:0
ds_read_b64_tr_b16 v[158:159], v66 offset:2048
ds_read_b64_tr_b16 v[160:161], v67 offset:0
ds_read_b64_tr_b16 v[162:163], v67 offset:2048
ds_read_b64_tr_b16 v[164:165], v68 offset:0
ds_read_b64_tr_b16 v[166:167], v68 offset:2048
ds_read_b64_tr_b16 v[168:169], v69 offset:0
ds_read_b64_tr_b16 v[170:171], v69 offset:2048
ds_read_b64_tr_b16 v[172:173], v66 offset:4096
ds_read_b64_tr_b16 v[174:175], v66 offset:6144
ds_read_b64_tr_b16 v[176:177], v67 offset:4096
ds_read_b64_tr_b16 v[178:179], v67 offset:6144
ds_read_b64_tr_b16 v[180:181], v68 offset:4096
ds_read_b64_tr_b16 v[182:183], v68 offset:6144
ds_read_b64_tr_b16 v[184:185], v69 offset:4096
ds_read_b64_tr_b16 v[186:187], v69 offset:6144
s_waitcnt vmcnt(9)
s_waitcnt lgkmcnt(8)
v_mfma_f32_16x16x32_bf16 v[76:79], v[156:159], v[92:95], 0
ds_read_b64_tr_b16 v[188:189], v66 offset:8192
ds_read_b64_tr_b16 v[190:191], v66 offset:10240
v_mfma_f32_16x16x32_bf16 v[80:83], v[160:163], v[92:95], 0
ds_read_b64_tr_b16 v[192:193], v67 offset:8192
ds_read_b64_tr_b16 v[194:195], v67 offset:10240
v_mfma_f32_16x16x32_bf16 v[84:87], v[164:167], v[92:95], 0
ds_read_b64_tr_b16 v[196:197], v68 offset:8192
ds_read_b64_tr_b16 v[198:199], v68 offset:10240
v_mfma_f32_16x16x32_bf16 v[88:91], v[168:171], v[92:95], 0
ds_read_b64_tr_b16 v[200:201], v69 offset:8192
ds_read_b64_tr_b16 v[202:203], v69 offset:10240
buffer_load_dwordx4 v[132:135], v70, s[44:47], s63 offen sc1
s_add_u32 s63, s63, 131072
s_waitcnt vmcnt(9)
s_waitcnt lgkmcnt(8)
v_mfma_f32_16x16x32_bf16 v[76:79], v[172:175], v[96:99], v[76:79]
ds_read_b64_tr_b16 v[156:157], v66 offset:12288
ds_read_b64_tr_b16 v[158:159], v66 offset:14336
v_mfma_f32_16x16x32_bf16 v[80:83], v[176:179], v[96:99], v[80:83]
ds_read_b64_tr_b16 v[160:161], v67 offset:12288
ds_read_b64_tr_b16 v[162:163], v67 offset:14336
v_mfma_f32_16x16x32_bf16 v[84:87], v[180:183], v[96:99], v[84:87]
ds_read_b64_tr_b16 v[164:165], v68 offset:12288
ds_read_b64_tr_b16 v[166:167], v68 offset:14336
v_mfma_f32_16x16x32_bf16 v[88:91], v[184:187], v[96:99], v[88:91]
ds_read_b64_tr_b16 v[168:169], v69 offset:12288
ds_read_b64_tr_b16 v[170:171], v69 offset:14336
buffer_load_dwordx4 v[136:139], v70, s[44:47], s63 offen sc1
s_add_u32 s63, s63, 131072
s_waitcnt vmcnt(9)
s_waitcnt lgkmcnt(8)
v_mfma_f32_16x16x32_bf16 v[76:79], v[188:191], v[100:103], v[76:79]
ds_read_b64_tr_b16 v[172:173], v66 offset:16384
ds_read_b64_tr_b16 v[174:175], v66 offset:18432
v_mfma_f32_16x16x32_bf16 v[80:83], v[192:195], v[100:103], v[80:83]
ds_read_b64_tr_b16 v[176:177], v67 offset:16384
ds_read_b64_tr_b16 v[178:179], v67 offset:18432
v_mfma_f32_16x16x32_bf16 v[84:87], v[196:199], v[100:103], v[84:87]
ds_read_b64_tr_b16 v[180:181], v68 offset:16384
ds_read_b64_tr_b16 v[182:183], v68 offset:18432
v_mfma_f32_16x16x32_bf16 v[88:91], v[200:203], v[100:103], v[88:91]
ds_read_b64_tr_b16 v[184:185], v69 offset:16384
ds_read_b64_tr_b16 v[186:187], v69 offset:18432
buffer_load_dwordx4 v[140:143], v70, s[44:47], s63 offen sc1
s_add_u32 s63, s63, 131072
s_waitcnt vmcnt(9)
s_waitcnt lgkmcnt(8)
v_mfma_f32_16x16x32_bf16 v[76:79], v[156:159], v[104:107], v[76:79]
ds_read_b64_tr_b16 v[188:189], v66 offset:20480
ds_read_b64_tr_b16 v[190:191], v66 offset:22528
v_mfma_f32_16x16x32_bf16 v[80:83], v[160:163], v[104:107], v[80:83]
ds_read_b64_tr_b16 v[192:193], v67 offset:20480
ds_read_b64_tr_b16 v[194:195], v67 offset:22528
v_mfma_f32_16x16x32_bf16 v[84:87], v[164:167], v[104:107], v[84:87]
ds_read_b64_tr_b16 v[196:197], v68 offset:20480
ds_read_b64_tr_b16 v[198:199], v68 offset:22528
v_mfma_f32_16x16x32_bf16 v[88:91], v[168:171], v[104:107], v[88:91]
ds_read_b64_tr_b16 v[200:201], v69 offset:20480
ds_read_b64_tr_b16 v[202:203], v69 offset:22528
buffer_load_dwordx4 v[144:147], v70, s[44:47], s63 offen sc1
s_add_u32 s63, s63, 131072
s_waitcnt vmcnt(9)
s_waitcnt lgkmcnt(8)
v_mfma_f32_16x16x32_bf16 v[76:79], v[172:175], v[108:111], v[76:79]
ds_read_b64_tr_b16 v[156:157], v66 offset:24576
ds_read_b64_tr_b16 v[158:159], v66 offset:26624
v_mfma_f32_16x16x32_bf16 v[80:83], v[176:179], v[108:111], v[80:83]
ds_read_b64_tr_b16 v[160:161], v67 offset:24576
ds_read_b64_tr_b16 v[162:163], v67 offset:26624
v_mfma_f32_16x16x32_bf16 v[84:87], v[180:183], v[108:111], v[84:87]
ds_read_b64_tr_b16 v[164:165], v68 offset:24576
ds_read_b64_tr_b16 v[166:167], v68 offset:26624
v_mfma_f32_16x16x32_bf16 v[88:91], v[184:187], v[108:111], v[88:91]
ds_read_b64_tr_b16 v[168:169], v69 offset:24576
ds_read_b64_tr_b16 v[170:171], v69 offset:26624
buffer_load_dwordx4 v[148:151], v70, s[44:47], s63 offen sc1
s_add_u32 s63, s63, 131072
s_waitcnt vmcnt(9)
s_waitcnt lgkmcnt(8)
v_mfma_f32_16x16x32_bf16 v[76:79], v[188:191], v[112:115], v[76:79]
ds_read_b64_tr_b16 v[172:173], v66 offset:28672
ds_read_b64_tr_b16 v[174:175], v66 offset:30720
v_mfma_f32_16x16x32_bf16 v[80:83], v[192:195], v[112:115], v[80:83]
ds_read_b64_tr_b16 v[176:177], v67 offset:28672
ds_read_b64_tr_b16 v[178:179], v67 offset:30720
v_mfma_f32_16x16x32_bf16 v[84:87], v[196:199], v[112:115], v[84:87]
ds_read_b64_tr_b16 v[180:181], v68 offset:28672
ds_read_b64_tr_b16 v[182:183], v68 offset:30720
v_mfma_f32_16x16x32_bf16 v[88:91], v[200:203], v[112:115], v[88:91]
ds_read_b64_tr_b16 v[184:185], v69 offset:28672
ds_read_b64_tr_b16 v[186:187], v69 offset:30720
buffer_load_dwordx4 v[152:155], v70, s[44:47], s63 offen sc1
s_add_u32 s63, s63, 131072
s_waitcnt vmcnt(9)
s_waitcnt lgkmcnt(8)
v_mfma_f32_16x16x32_bf16 v[76:79], v[156:159], v[116:119], v[76:79]
ds_read_b64_tr_b16 v[188:189], v66 offset:32768
ds_read_b64_tr_b16 v[190:191], v66 offset:34816
v_mfma_f32_16x16x32_bf16 v[80:83], v[160:163], v[116:119], v[80:83]
ds_read_b64_tr_b16 v[192:193], v67 offset:32768
ds_read_b64_tr_b16 v[194:195], v67 offset:34816
v_mfma_f32_16x16x32_bf16 v[84:87], v[164:167], v[116:119], v[84:87]
ds_read_b64_tr_b16 v[196:197], v68 offset:32768
ds_read_b64_tr_b16 v[198:199], v68 offset:34816
v_mfma_f32_16x16x32_bf16 v[88:91], v[168:171], v[116:119], v[88:91]
ds_read_b64_tr_b16 v[200:201], v69 offset:32768
ds_read_b64_tr_b16 v[202:203], v69 offset:34816
s_waitcnt vmcnt(8)
s_waitcnt lgkmcnt(8)
v_mfma_f32_16x16x32_bf16 v[76:79], v[172:175], v[120:123], v[76:79]
ds_read_b64_tr_b16 v[156:157], v66 offset:36864
ds_read_b64_tr_b16 v[158:159], v66 offset:38912
v_mfma_f32_16x16x32_bf16 v[80:83], v[176:179], v[120:123], v[80:83]
ds_read_b64_tr_b16 v[160:161], v67 offset:36864
ds_read_b64_tr_b16 v[162:163], v67 offset:38912
v_mfma_f32_16x16x32_bf16 v[84:87], v[180:183], v[120:123], v[84:87]
ds_read_b64_tr_b16 v[164:165], v68 offset:36864
ds_read_b64_tr_b16 v[166:167], v68 offset:38912
v_mfma_f32_16x16x32_bf16 v[88:91], v[184:187], v[120:123], v[88:91]
ds_read_b64_tr_b16 v[168:169], v69 offset:36864
ds_read_b64_tr_b16 v[170:171], v69 offset:38912
s_waitcnt vmcnt(7)
s_waitcnt lgkmcnt(8)
v_mfma_f32_16x16x32_bf16 v[76:79], v[188:191], v[124:127], v[76:79]
ds_read_b64_tr_b16 v[172:173], v66 offset:40960
ds_read_b64_tr_b16 v[174:175], v66 offset:43008
v_mfma_f32_16x16x32_bf16 v[80:83], v[192:195], v[124:127], v[80:83]
ds_read_b64_tr_b16 v[176:177], v67 offset:40960
ds_read_b64_tr_b16 v[178:179], v67 offset:43008
v_mfma_f32_16x16x32_bf16 v[84:87], v[196:199], v[124:127], v[84:87]
ds_read_b64_tr_b16 v[180:181], v68 offset:40960
ds_read_b64_tr_b16 v[182:183], v68 offset:43008
v_mfma_f32_16x16x32_bf16 v[88:91], v[200:203], v[124:127], v[88:91]
ds_read_b64_tr_b16 v[184:185], v69 offset:40960
ds_read_b64_tr_b16 v[186:187], v69 offset:43008
s_waitcnt vmcnt(6)
s_waitcnt lgkmcnt(8)
v_mfma_f32_16x16x32_bf16 v[76:79], v[156:159], v[128:131], v[76:79]
ds_read_b64_tr_b16 v[188:189], v66 offset:45056
ds_read_b64_tr_b16 v[190:191], v66 offset:47104
v_mfma_f32_16x16x32_bf16 v[80:83], v[160:163], v[128:131], v[80:83]
ds_read_b64_tr_b16 v[192:193], v67 offset:45056
ds_read_b64_tr_b16 v[194:195], v67 offset:47104
v_mfma_f32_16x16x32_bf16 v[84:87], v[164:167], v[128:131], v[84:87]
ds_read_b64_tr_b16 v[196:197], v68 offset:45056
ds_read_b64_tr_b16 v[198:199], v68 offset:47104
v_mfma_f32_16x16x32_bf16 v[88:91], v[168:171], v[128:131], v[88:91]
ds_read_b64_tr_b16 v[200:201], v69 offset:45056
ds_read_b64_tr_b16 v[202:203], v69 offset:47104
s_waitcnt vmcnt(5)
s_waitcnt lgkmcnt(8)
v_mfma_f32_16x16x32_bf16 v[76:79], v[172:175], v[132:135], v[76:79]
ds_read_b64_tr_b16 v[156:157], v66 offset:49152
ds_read_b64_tr_b16 v[158:159], v66 offset:51200
v_mfma_f32_16x16x32_bf16 v[80:83], v[176:179], v[132:135], v[80:83]
ds_read_b64_tr_b16 v[160:161], v67 offset:49152
ds_read_b64_tr_b16 v[162:163], v67 offset:51200
v_mfma_f32_16x16x32_bf16 v[84:87], v[180:183], v[132:135], v[84:87]
ds_read_b64_tr_b16 v[164:165], v68 offset:49152
ds_read_b64_tr_b16 v[166:167], v68 offset:51200
v_mfma_f32_16x16x32_bf16 v[88:91], v[184:187], v[132:135], v[88:91]
ds_read_b64_tr_b16 v[168:169], v69 offset:49152
ds_read_b64_tr_b16 v[170:171], v69 offset:51200
s_waitcnt vmcnt(4)
s_waitcnt lgkmcnt(8)
v_mfma_f32_16x16x32_bf16 v[76:79], v[188:191], v[136:139], v[76:79]
ds_read_b64_tr_b16 v[172:173], v66 offset:53248
ds_read_b64_tr_b16 v[174:175], v66 offset:55296
v_mfma_f32_16x16x32_bf16 v[80:83], v[192:195], v[136:139], v[80:83]
ds_read_b64_tr_b16 v[176:177], v67 offset:53248
ds_read_b64_tr_b16 v[178:179], v67 offset:55296
v_mfma_f32_16x16x32_bf16 v[84:87], v[196:199], v[136:139], v[84:87]
ds_read_b64_tr_b16 v[180:181], v68 offset:53248
ds_read_b64_tr_b16 v[182:183], v68 offset:55296
v_mfma_f32_16x16x32_bf16 v[88:91], v[200:203], v[136:139], v[88:91]
ds_read_b64_tr_b16 v[184:185], v69 offset:53248
ds_read_b64_tr_b16 v[186:187], v69 offset:55296
s_waitcnt vmcnt(3)
s_waitcnt lgkmcnt(8)
v_mfma_f32_16x16x32_bf16 v[76:79], v[156:159], v[140:143], v[76:79]
ds_read_b64_tr_b16 v[188:189], v66 offset:57344
ds_read_b64_tr_b16 v[190:191], v66 offset:59392
v_mfma_f32_16x16x32_bf16 v[80:83], v[160:163], v[140:143], v[80:83]
ds_read_b64_tr_b16 v[192:193], v67 offset:57344
ds_read_b64_tr_b16 v[194:195], v67 offset:59392
v_mfma_f32_16x16x32_bf16 v[84:87], v[164:167], v[140:143], v[84:87]
ds_read_b64_tr_b16 v[196:197], v68 offset:57344
ds_read_b64_tr_b16 v[198:199], v68 offset:59392
v_mfma_f32_16x16x32_bf16 v[88:91], v[168:171], v[140:143], v[88:91]
ds_read_b64_tr_b16 v[200:201], v69 offset:57344
ds_read_b64_tr_b16 v[202:203], v69 offset:59392
s_waitcnt vmcnt(2)
s_waitcnt lgkmcnt(8)
v_mfma_f32_16x16x32_bf16 v[76:79], v[172:175], v[144:147], v[76:79]
ds_read_b64_tr_b16 v[156:157], v66 offset:61440
ds_read_b64_tr_b16 v[158:159], v66 offset:63488
v_mfma_f32_16x16x32_bf16 v[80:83], v[176:179], v[144:147], v[80:83]
ds_read_b64_tr_b16 v[160:161], v67 offset:61440
ds_read_b64_tr_b16 v[162:163], v67 offset:63488
v_mfma_f32_16x16x32_bf16 v[84:87], v[180:183], v[144:147], v[84:87]
ds_read_b64_tr_b16 v[164:165], v68 offset:61440
ds_read_b64_tr_b16 v[166:167], v68 offset:63488
v_mfma_f32_16x16x32_bf16 v[88:91], v[184:187], v[144:147], v[88:91]
ds_read_b64_tr_b16 v[168:169], v69 offset:61440
ds_read_b64_tr_b16 v[170:171], v69 offset:63488
s_waitcnt vmcnt(1)
s_waitcnt lgkmcnt(8)
v_mfma_f32_16x16x32_bf16 v[76:79], v[188:191], v[148:151], v[76:79]
v_mfma_f32_16x16x32_bf16 v[80:83], v[192:195], v[148:151], v[80:83]
v_mfma_f32_16x16x32_bf16 v[84:87], v[196:199], v[148:151], v[84:87]
v_mfma_f32_16x16x32_bf16 v[88:91], v[200:203], v[148:151], v[88:91]
s_mov_b64 exec, 0xff
buffer_load_dword v254, v252, s[44:47], s66 offen sc1
s_mov_b64 exec, -1
s_waitcnt vmcnt(1)
s_waitcnt lgkmcnt(0)
v_mfma_f32_16x16x32_bf16 v[76:79], v[156:159], v[152:155], v[76:79]
v_mfma_f32_16x16x32_bf16 v[80:83], v[160:163], v[152:155], v[80:83]
v_mfma_f32_16x16x32_bf16 v[84:87], v[164:167], v[152:155], v[84:87]
v_mfma_f32_16x16x32_bf16 v[88:91], v[168:171], v[152:155], v[88:91]
s_lshl_b32 s63, s6, 18
s_lshl_b32 s3, s5, 10
s_add_u32 s63, s63, s3
s_lshl_b32 s3, s4, 8
s_add_u32 s63, s63, s3
s_add_u32 s63, s63, 3145728
s_add_u32 s64, s63, 131072
v_lshlrev_b32 v1, 15, v57
v_lshl_add_u32 v1, v56, 4, v1
v_pk_add_f32 v[76:77], v[76:77], v[32:33]
v_pk_add_f32 v[78:79], v[78:79], v[34:35]
v_pk_add_f32 v[80:81], v[80:81], v[36:37]
v_pk_add_f32 v[82:83], v[82:83], v[38:39]
v_cvt_pk_bf16_f32 v48, v76, v77
v_cvt_pk_bf16_f32 v49, v78, v79
v_cvt_pk_bf16_f32 v50, v80, v81
v_cvt_pk_bf16_f32 v51, v82, v83
buffer_store_dwordx4 v[48:51], v1, s[44:47], s63 offen sc1
v_pk_add_f32 v[84:85], v[84:85], v[40:41]
v_pk_add_f32 v[86:87], v[86:87], v[42:43]
v_pk_add_f32 v[88:89], v[88:89], v[44:45]
v_pk_add_f32 v[90:91], v[90:91], v[46:47]
v_cvt_pk_bf16_f32 v52, v84, v85
v_cvt_pk_bf16_f32 v53, v86, v87
v_cvt_pk_bf16_f32 v54, v88, v89
v_cvt_pk_bf16_f32 v55, v90, v91
buffer_store_dwordx4 v[52:55], v1, s[44:47], s64 offen sc1
v_dot2_f32_bf16 v92, v48, v61, 0
v_dot2_f32_bf16 v93, v48, v48, 0
v_dot2_f32_bf16 v92, v49, v61, v92
v_dot2_f32_bf16 v93, v49, v49, v93
v_dot2_f32_bf16 v92, v50, v61, v92
v_dot2_f32_bf16 v93, v50, v50, v93
v_dot2_f32_bf16 v92, v51, v61, v92
v_dot2_f32_bf16 v93, v51, v51, v93
v_dot2_f32_bf16 v92, v52, v61, v92
v_dot2_f32_bf16 v93, v52, v52, v93
v_dot2_f32_bf16 v92, v53, v61, v92
v_dot2_f32_bf16 v93, v53, v53, v93
v_dot2_f32_bf16 v92, v54, v61, v92
v_dot2_f32_bf16 v93, v54, v54, v93
v_dot2_f32_bf16 v92, v55, v61, v92
v_dot2_f32_bf16 v93, v55, v55, v93
s_lshl_b32 s63, s6, 14
s_lshl_b32 s3, s5, 9
s_add_u32 s63, s63, s3
v_permlane32_swap_b32 v92, v93
v_lshrrev_b32 v2, 1, v57
v_lshlrev_b32 v2, 6, v2
v_add_f32 v92, v92, v93
s_lshl_b32 s3, s4, 7
s_add_u32 s63, s63, s3
v_mov_b32 v94, v92
v_lshl_add_u32 v2, v56, 2, v2
s_add_u32 s63, s63, 17825792
v_permlane16_swap_b32 v92, v94
v_add_f32 v92, v92, v94
s_mov_b32 exec_lo, 0xffff
s_mov_b32 exec_hi, 0xffff
buffer_store_dword v92, v2, s[44:47], s63 offen sc1
s_mov_b64 exec, -1
s_barrier
s_lshl_b32 s73, s5, 7
s_add_u32 s73, s73, 4096
s_add_u32 s72, s68, 458752
s_add_u32 m0, s69, 28672
s_nop 0
buffer_load_dwordx4 v244, s[28:31], s72 offen offset:0 lds
buffer_load_dwordx4 v245, s[28:31], s72 offen offset:1024 lds
buffer_load_dwordx4 v246, s[28:31], s72 offen offset:2048 lds
buffer_load_dwordx4 v247, s[28:31], s72 offen offset:3072 lds
s_add_u32 m0, s69, 32768
s_nop 0
buffer_load_dwordx4 v248, s[28:31], s72 offen offset:0 lds
buffer_load_dwordx4 v249, s[28:31], s72 offen offset:1024 lds
buffer_load_dwordx4 v250, s[28:31], s72 offen offset:2048 lds
s_add_u32 s72, s68, 917504
s_add_u32 m0, s69, 65536
s_nop 0
buffer_load_dwordx4 v244, s[28:31], s72 offen offset:0 lds
s_waitcnt vmcnt(8)
s_barrier
s_cmp_lg_u32 s4, 0
s_cbranch_scc1 L_sig_10
s_mov_b64 exec, 1
v_mov_b32 v255, 1
buffer_atomic_add v255, v62, s[44:47], s73 offen sc1
s_mov_b64 exec, -1
L_sig_10:
buffer_load_dwordx4 v245, s[28:31], s72 offen offset:1024 lds
buffer_load_dwordx4 v246, s[28:31], s72 offen offset:2048 lds
buffer_load_dwordx4 v247, s[28:31], s72 offen offset:3072 lds
s_add_u32 m0, s69, 69632
s_nop 0
buffer_load_dwordx4 v248, s[28:31], s72 offen offset:0 lds
buffer_load_dwordx4 v249, s[28:31], s72 offen offset:1024 lds
buffer_load_dwordx4 v250, s[28:31], s72 offen offset:2048 lds
s_add_u32 s72, s68, 1376256
s_add_u32 m0, s69, 94208
s_nop 0
buffer_load_dwordx4 v244, s[28:31], s72 offen offset:0 lds
buffer_load_dwordx4 v245, s[28:31], s72 offen offset:1024 lds
buffer_load_dwordx4 v246, s[28:31], s72 offen offset:2048 lds
buffer_load_dwordx4 v247, s[28:31], s72 offen offset:3072 lds
s_add_u32 m0, s69, 98304
s_nop 0
buffer_load_dwordx4 v248, s[28:31], s72 offen offset:0 lds
buffer_load_dwordx4 v249, s[28:31], s72 offen offset:1024 lds
buffer_load_dwordx4 v250, s[28:31], s72 offen offset:2048 lds
s_lshl_b32 s3, s4, 11
s_lshl_b32 s72, s2, 13
s_add_u32 s72, s72, s3
s_lshl_b32 s63, s78, 5
s_add_u32 s63, s63, s3
s_add_u32 m0, s63, 149536
s_lshl_b32 s63, s78, 8
s_add_u32 s63, s63, s3
buffer_load_dwordx4 v12, s[36:39], s72 offen lds
buffer_load_dwordx4 v12, s[36:39], s72 offen offset:1024 lds
v_mov_b32 v4, 0
v_mov_b32 v5, 0
v_mov_b32 v6, 0
v_mov_b32 v7, 0
s_mul_i32 s64, s78, 4352
v_add_u32 v2, s64, v12
v_add_u32 v2, 131072, v2
s_mul_i32 s65, s78, 4128
v_add_u32 v3, s65, v12
v_add_u32 v3, 149504, v3
s_mov_b64 exec, 0xffff
ds_write_b128 v2, v[4:7]
s_mov_b64 exec, 3
ds_write_b128 v3, v[4:7]
s_mul_i32 s64, s78, 528
s_add_u32 s64, s64, 157760
v_mov_b32 v2, s64
s_mov_b64 exec, 1
ds_write_b128 v2, v[4:7]
s_mov_b64 exec, -1
s_mov_b64 exec, 0xff
v_cmp_gt_u32 vcc, 4, v254
s_mov_b64 exec, -1
s_cbranch_vccz L_ck_11
s_mov_b64 exec, 0xff
s_mov_b32 s3, 0
L_poll_12:
buffer_load_dword v255, v252, s[44:47], s66 offen sc1
s_add_u32 s3, s3, 1
s_cmp_gt_u32 s3, 400000
s_cbranch_scc1 L_pollx_13
s_waitcnt vmcnt(0)
v_cmp_gt_u32 vcc, 4, v255
s_cbranch_vccnz L_poll_12
L_pollx_13:
s_waitcnt vmcnt(0)
s_mov_b64 exec, -1
L_ck_11:
s_add_u32 m0, s63, 131328
s_add_u32 s72, s72, 13631488
buffer_load_dwordx4 v12, s[44:47], s72 offen sc1 lds
buffer_load_dwordx4 v12, s[44:47], s72 offen offset:1024 sc1 lds
s_lshl_b32 s63, s60, 7
s_lshl_b32 s3, s4, 5
s_add_u32 s63, s63, s3
v_add_u32 v1, s63, v56
v_lshlrev_b32 v2, 15, v57
v_lshl_add_u32 v7, v1, 4, v2
s_lshl_b32 s64, s63, 3
s_add_u32 s64, s64, 17825792
v_lshl_add_u32 v5, v56, 2, v2
v_add_u32 v6, 16384, v5
s_lshl_b32 s65, s60, 8
s_add_u32 s65, s65, 4096
v_lshlrev_b32 v3, 7, v58
s_mov_b32 s63, 3145728
s_waitcnt lgkmcnt(0)
s_cmp_lg_u32 s4, 0
s_cbranch_scc1 L_wf_14
s_mov_b64 exec, 3
s_mov_b32 s3, 0
L_poll_15:
buffer_load_dword v255, v3, s[44:47], s65 offen sc1
s_add_u32 s3, s3, 1
s_cmp_gt_u32 s3, 400000
s_cbranch_scc1 L_pollx_16
s_waitcnt vmcnt(0)
v_cmp_gt_u32 vcc, 8, v255
s_cbranch_vccnz L_poll_15
L_pollx_16:
s_waitcnt vmcnt(0)
s_mov_b64 exec, -1
L_wf_14:
s_barrier
buffer_load_dwordx4 a[0:3], v7, s[44:47], s63 offen sc1
buffer_load_dwordx4 a[4:7], v7, s[44:47], s63 offen offset:256 sc1
s_add_u32 s63, s63, 131072
buffer_load_dwordx4 a[8:11], v7, s[44:47], s63 offen sc1
buffer_load_dwordx4 a[12:15], v7, s[44:47], s63 offen offset:256 sc1
s_add_u32 s63, s63, 131072
buffer_load_dwordx4 a[16:19], v7, s[44:47], s63 offen sc1
buffer_load_dwordx4 a[20:23], v7, s[44:47], s63 offen offset:256 sc1
s_add_u32 s63, s63, 131072
buffer_load_dwordx4 a[24:27], v7, s[44:47], s63 offen sc1
buffer_load_dwordx4 a[28:31], v7, s[44:47], s63 offen offset:256 sc1
s_add_u32 s63, s63, 131072
buffer_load_dwordx4 a[32:35], v7, s[44:47], s63 offen sc1
buffer_load_dwordx4 a[36:39], v7, s[44:47], s63 offen offset:256 sc1
s_add_u32 s63, s63, 131072
s_waitcnt vmcnt(10)
s_barrier
s_lshl_b32 s3, s4, 5
s_add_u32 s67, s3, 128
s_min_u32 s67, s67, 192
v_add_u32 v1, s3, v64
v_add_u32 v2, s67, v64
v_mov_b32 v164, v61
v_mov_b32 v165, v61
v_mov_b32 v166, v61
v_mov_b32 v167, v61
ds_read_b64_tr_b16 v[168:169], v1 offset:0
ds_read_b64_tr_b16 v[170:171], v1 offset:3584
ds_read_b64_tr_b16 v[172:173], v2 offset:0
ds_read_b64_tr_b16 v[174:175], v2 offset:3584
ds_read_b64_tr_b16 v[176:177], v1 offset:7168
ds_read_b64_tr_b16 v[178:179], v1 offset:10752
ds_read_b64_tr_b16 v[180:181], v2 offset:7168
ds_read_b64_tr_b16 v[182:183], v2 offset:10752
ds_read_b64_tr_b16 v[184:185], v1 offset:14336
ds_read_b64_tr_b16 v[186:187], v1 offset:17920
ds_read_b64_tr_b16 v[188:189], v2 offset:14336
ds_read_b64_tr_b16 v[190:191], v2 offset:17920
ds_read_b64_tr_b16 v[192:193], v1 offset:21504
ds_read_b64_tr_b16 v[194:195], v1 offset:25088
ds_read_b64_tr_b16 v[196:197], v2 offset:21504
ds_read_b64_tr_b16 v[198:199], v2 offset:25088
ds_read_b64_tr_b16 v[200:201], v1 offset:28672
ds_read_b64_tr_b16 v[202:203], v1 offset:32256
ds_read_b64_tr_b16 v[204:205], v2 offset:28672
ds_read_b64_tr_b16 v[206:207], v2 offset:32256
ds_read_b64_tr_b16 v[208:209], v1 offset:35840
ds_read_b64_tr_b16 v[210:211], v1 offset:39424
ds_read_b64_tr_b16 v[212:213], v2 offset:35840
ds_read_b64_tr_b16 v[214:215], v2 offset:39424
ds_read_b64_tr_b16 v[216:217], v1 offset:43008
ds_read_b64_tr_b16 v[218:219], v1 offset:46592
ds_read_b64_tr_b16 v[220:221], v2 offset:43008
ds_read_b64_tr_b16 v[222:223], v2 offset:46592
ds_read_b64_tr_b16 v[224:225], v1 offset:50176
ds_read_b64_tr_b16 v[226:227], v1 offset:53760
ds_read_b64_tr_b16 v[228:229], v2 offset:50176
ds_read_b64_tr_b16 v[230:231], v2 offset:53760
s_waitcnt lgkmcnt(15)
v_mfma_f32_16x16x32_bf16 a[128:131], v[168:171], v[164:167], 0
v_mfma_f32_16x16x32_bf16 a[132:135], v[172:175], v[164:167], 0
v_mfma_f32_16x16x32_bf16 a[128:131], v[176:179], v[164:167], a[128:131]
v_mfma_f32_16x16x32_bf16 a[132:135], v[180:183], v[164:167], a[132:135]
v_mfma_f32_16x16x32_bf16 a[128:131], v[184:187], v[164:167], a[128:131]
v_mfma_f32_16x16x32_bf16 a[132:135], v[188:191], v[164:167], a[132:135]
v_mfma_f32_16x16x32_bf16 a[128:131], v[192:195], v[164:167], a[128:131]
v_mfma_f32_16x16x32_bf16 a[132:135], v[196:199], v[164:167], a[132:135]
s_waitcnt lgkmcnt(0)
v_mfma_f32_16x16x32_bf16 a[128:131], v[200:203], v[164:167], a[128:131]
v_mfma_f32_16x16x32_bf16 a[132:135], v[204:207], v[164:167], a[132:135]
v_mfma_f32_16x16x32_bf16 a[128:131], v[208:211], v[164:167], a[128:131]
v_mfma_f32_16x16x32_bf16 a[132:135], v[212:215], v[164:167], a[132:135]
v_mfma_f32_16x16x32_bf16 a[128:131], v[216:219], v[164:167], a[128:131]
v_mfma_f32_16x16x32_bf16 a[132:135], v[220:223], v[164:167], a[132:135]
v_mfma_f32_16x16x32_bf16 a[128:131], v[224:227], v[164:167], a[128:131]
v_mfma_f32_16x16x32_bf16 a[132:135], v[228:231], v[164:167], a[132:135]
s_lshl_b32 s3, s4, 5
s_add_u32 s67, s3, 128
s_min_u32 s67, s67, 192
v_add_u32 v1, s3, v65
v_add_u32 v2, s67, v65
v_mov_b32 v164, v61
v_mov_b32 v165, v61
v_mov_b32 v166, v61
v_mov_b32 v167, v61
ds_read_b64_tr_b16 v[168:169], v1 offset:0
ds_read_b64_tr_b16 v[170:171], v1 offset:3584
ds_read_b64_tr_b16 v[172:173], v2 offset:0
ds_read_b64_tr_b16 v[174:175], v2 offset:3584
ds_read_b64_tr_b16 v[176:177], v1 offset:7168
ds_read_b64_tr_b16 v[178:179], v1 offset:10752
ds_read_b64_tr_b16 v[180:181], v2 offset:7168
ds_read_b64_tr_b16 v[182:183], v2 offset:10752
ds_read_b64_tr_b16 v[184:185], v1 offset:14336
ds_read_b64_tr_b16 v[186:187], v1 offset:17920
ds_read_b64_tr_b16 v[188:189], v2 offset:14336
ds_read_b64_tr_b16 v[190:191], v2 offset:17920
ds_read_b64_tr_b16 v[192:193], v1 offset:21504
ds_read_b64_tr_b16 v[194:195], v1 offset:25088
ds_read_b64_tr_b16 v[196:197], v2 offset:21504
ds_read_b64_tr_b16 v[198:199], v2 offset:25088
ds_read_b64_tr_b16 v[200:201], v1 offset:28672
ds_read_b64_tr_b16 v[202:203], v1 offset:32256
ds_read_b64_tr_b16 v[204:205], v2 offset:28672
ds_read_b64_tr_b16 v[206:207], v2 offset:32256
ds_read_b64_tr_b16 v[208:209], v1 offset:35840
ds_read_b64_tr_b16 v[210:211], v1 offset:39424
ds_read_b64_tr_b16 v[212:213], v2 offset:35840
ds_read_b64_tr_b16 v[214:215], v2 offset:39424
ds_read_b64_tr_b16 v[216:217], v1 offset:43008
ds_read_b64_tr_b16 v[218:219], v1 offset:46592
ds_read_b64_tr_b16 v[220:221], v2 offset:43008
ds_read_b64_tr_b16 v[222:223], v2 offset:46592
ds_read_b64_tr_b16 v[224:225], v1 offset:50176
ds_read_b64_tr_b16 v[226:227], v1 offset:53760
ds_read_b64_tr_b16 v[228:229], v2 offset:50176
ds_read_b64_tr_b16 v[230:231], v2 offset:53760
s_waitcnt lgkmcnt(15)
v_mfma_f32_16x16x32_bf16 a[128:131], v[168:171], v[164:167], a[128:131]
v_mfma_f32_16x16x32_bf16 a[132:135], v[172:175], v[164:167], a[132:135]
v_mfma_f32_16x16x32_bf16 a[128:131], v[176:179], v[164:167], a[128:131]
v_mfma_f32_16x16x32_bf16 a[132:135], v[180:183], v[164:167], a[132:135]
v_mfma_f32_16x16x32_bf16 a[128:131], v[184:187], v[164:167], a[128:131]
v_mfma_f32_16x16x32_bf16 a[132:135], v[188:191], v[164:167], a[132:135]
v_mfma_f32_16x16x32_bf16 a[128:131], v[192:195], v[164:167], a[128:131]
v_mfma_f32_16x16x32_bf16 a[132:135], v[196:199], v[164:167], a[132:135]
s_waitcnt lgkmcnt(0)
v_mfma_f32_16x16x32_bf16 a[128:131], v[200:203], v[164:167], a[128:131]
v_mfma_f32_16x16x32_bf16 a[132:135], v[204:207], v[164:167], a[132:135]
v_mfma_f32_16x16x32_bf16 a[128:131], v[208:211], v[164:167], a[128:131]
v_mfma_f32_16x16x32_bf16 a[132:135], v[212:215], v[164:167], a[132:135]
v_mfma_f32_16x16x32_bf16 a[128:131], v[216:219], v[164:167], a[128:131]
v_mfma_f32_16x16x32_bf16 a[132:135], v[220:223], v[164:167], a[132:135]
v_mfma_f32_16x16x32_bf16 a[128:131], v[224:227], v[164:167], a[128:131]
v_mfma_f32_16x16x32_bf16 a[132:135], v[228:231], v[164:167], a[132:135]
v_lshlrev_b32 v1, 4, v57
s_lshl_b32 s3, s3, 1
s_lshl_b32 s67, s67, 1
v_add_u32 v2, s67, v1
v_add_u32 v1, s3, v1
v_add_u32 v1, 158848, v1
v_add_u32 v2, 158848, v2
ds_read_b64_tr_b16 v[172:173], v64 offset:0
ds_read_b64_tr_b16 v[174:175], v64 offset:3584
ds_read_b64_tr_b16 v[176:177], v64 offset:32
ds_read_b64_tr_b16 v[178:179], v64 offset:3616
ds_read_b64_tr_b16 v[180:181], v64 offset:64
ds_read_b64_tr_b16 v[182:183], v64 offset:3648
ds_read_b64_tr_b16 v[184:185], v64 offset:96
ds_read_b64_tr_b16 v[186:187], v64 offset:3680
ds_read_b64_tr_b16 v[188:189], v64 offset:128
ds_read_b64_tr_b16 v[190:191], v64 offset:3712
ds_read_b64_tr_b16 v[192:193], v64 offset:160
ds_read_b64_tr_b16 v[194:195], v64 offset:3744
ds_read_b64_tr_b16 v[196:197], v64 offset:192
ds_read_b64_tr_b16 v[198:199], v64 offset:3776
s_mov_b32 exec_lo, 0x00010001
s_mov_b32 exec_hi, 0x00010001
ds_write_b128 v1, a[128:131]
ds_write_b128 v2, a[132:135]
s_mov_b64 exec, -1
s_waitcnt vmcnt(8)
s_waitcnt lgkmcnt(0)
v_mfma_f32_16x16x32_bf16 v[66:69], v[172:175], a[0:3], 0
ds_read_b64_tr_b16 v[200:201], v64 offset:7168
ds_read_b64_tr_b16 v[202:203], v64 offset:10752
v_mfma_f32_16x16x32_bf16 v[94:97], v[172:175], a[4:7], 0
ds_read_b64_tr_b16 v[204:205], v64 offset:7200
ds_read_b64_tr_b16 v[206:207], v64 offset:10784
v_mfma_f32_16x16x32_bf16 v[70:73], v[176:179], a[0:3], 0
ds_read_b64_tr_b16 v[208:209], v64 offset:7232
ds_read_b64_tr_b16 v[210:211], v64 offset:10816
v_mfma_f32_16x16x32_bf16 v[98:101], v[176:179], a[4:7], 0
ds_read_b64_tr_b16 v[212:213], v64 offset:7264
ds_read_b64_tr_b16 v[214:215], v64 offset:10848
v_mfma_f32_16x16x32_bf16 v[74:77], v[180:183], a[0:3], 0
ds_read_b64_tr_b16 v[216:217], v64 offset:7296
ds_read_b64_tr_b16 v[218:219], v64 offset:10880
v_mfma_f32_16x16x32_bf16 v[102:105], v[180:183], a[4:7], 0
ds_read_b64_tr_b16 v[220:221], v64 offset:7328
ds_read_b64_tr_b16 v[222:223], v64 offset:10912
v_mfma_f32_16x16x32_bf16 v[78:81], v[184:187], a[0:3], 0
ds_read_b64_tr_b16 v[224:225], v64 offset:7360
ds_read_b64_tr_b16 v[226:227], v64 offset:10944
v_mfma_f32_16x16x32_bf16 v[106:109], v[184:187], a[4:7], 0
buffer_load_dwordx4 a[40:43], v7, s[44:47], s63 offen sc1
v_mfma_f32_16x16x32_bf16 v[82:85], v[188:191], a[0:3], 0
v_lshrrev_b32 v1, 3, v58
v_and_b32 v2, 7, v0
v_mfma_f32_16x16x32_bf16 v[110:113], v[188:191], a[4:7], 0
buffer_load_dwordx4 a[44:47], v7, s[44:47], s63 offen offset:256 sc1
s_add_u32 s63, s63, 131072
v_mfma_f32_16x16x32_bf16 v[86:89], v[192:195], a[0:3], 0
v_and_b32 v3, 1, v57
v_lshlrev_b32 v3, 1, v3
v_mfma_f32_16x16x32_bf16 v[114:117], v[192:195], a[4:7], 0
buffer_load_dwordx4 a[48:51], v7, s[44:47], s63 offen sc1
v_mfma_f32_16x16x32_bf16 v[90:93], v[196:199], a[0:3], 0
v_xor_b32 v3, v3, v2
v_lshlrev_b32 v1, 10, v1
v_mfma_f32_16x16x32_bf16 v[118:121], v[196:199], a[4:7], 0
buffer_load_dwordx4 a[52:55], v7, s[44:47], s63 offen offset:256 sc1
s_add_u32 s63, s63, 131072
s_waitcnt vmcnt(10)
s_waitcnt lgkmcnt(0)
v_mfma_f32_16x16x32_bf16 v[66:69], v[200:203], a[8:11], v[66:69]
ds_read_b64_tr_b16 v[172:173], v64 offset:14336
ds_read_b64_tr_b16 v[174:175], v64 offset:17920
v_mfma_f32_16x16x32_bf16 v[94:97], v[200:203], a[12:15], v[94:97]
ds_read_b64_tr_b16 v[176:177], v64 offset:14368
ds_read_b64_tr_b16 v[178:179], v64 offset:17952
v_mfma_f32_16x16x32_bf16 v[70:73], v[204:207], a[8:11], v[70:73]
ds_read_b64_tr_b16 v[180:181], v64 offset:14400
ds_read_b64_tr_b16 v[182:183], v64 offset:17984
v_mfma_f32_16x16x32_bf16 v[98:101], v[204:207], a[12:15], v[98:101]
ds_read_b64_tr_b16 v[184:185], v64 offset:14432
ds_read_b64_tr_b16 v[186:187], v64 offset:18016
v_mfma_f32_16x16x32_bf16 v[74:77], v[208:211], a[8:11], v[74:77]
ds_read_b64_tr_b16 v[188:189], v64 offset:14464
ds_read_b64_tr_b16 v[190:191], v64 offset:18048
v_mfma_f32_16x16x32_bf16 v[102:105], v[208:211], a[12:15], v[102:105]
ds_read_b64_tr_b16 v[192:193], v64 offset:14496
ds_read_b64_tr_b16 v[194:195], v64 offset:18080
v_mfma_f32_16x16x32_bf16 v[78:81], v[212:215], a[8:11], v[78:81]
ds_read_b64_tr_b16 v[196:197], v64 offset:14528
ds_read_b64_tr_b16 v[198:199], v64 offset:18112
v_mfma_f32_16x16x32_bf16 v[106:109], v[212:215], a[12:15], v[106:109]
buffer_load_dwordx4 a[56:59], v7, s[44:47], s63 offen sc1
v_mfma_f32_16x16x32_bf16 v[82:85], v[216:219], a[8:11], v[82:85]
v_lshl_add_u32 v8, v3, 4, v1
v_xor_b32 v9, 64, v8
v_mfma_f32_16x16x32_bf16 v[110:113], v[216:219], a[12:15], v[110:113]
buffer_load_dwordx4 a[60:63], v7, s[44:47], s63 offen offset:256 sc1
s_add_u32 s63, s63, 131072
v_mfma_f32_16x16x32_bf16 v[86:89], v[220:223], a[8:11], v[86:89]
v_add_u32 v10, 14336, v8
v_add_u32 v11, 21504, v9
v_mfma_f32_16x16x32_bf16 v[114:117], v[220:223], a[12:15], v[114:117]
buffer_load_dwordx4 a[64:67], v7, s[44:47], s63 offen sc1
v_mfma_f32_16x16x32_bf16 v[90:93], v[224:227], a[8:11], v[90:93]
v_add_u32 v9, 7168, v9
s_mul_i32 s70, s79, 917504
v_mfma_f32_16x16x32_bf16 v[118:121], v[224:227], a[12:15], v[118:121]
buffer_load_dwordx4 a[68:71], v7, s[44:47], s63 offen offset:256 sc1
s_add_u32 s63, s63, 131072
s_waitcnt vmcnt(12)
s_waitcnt lgkmcnt(0)
v_mfma_f32_16x16x32_bf16 v[66:69], v[172:175], a[16:19], v[66:69]
ds_read_b64_tr_b16 v[200:201], v64 offset:21504
ds_read_b64_tr_b16 v[202:203], v64 offset:25088
v_mfma_f32_16x16x32_bf16 v[94:97], v[172:175], a[20:23], v[94:97]
ds_read_b64_tr_b16 v[204:205], v64 offset:21536
ds_read_b64_tr_b16 v[206:207], v64 offset:25120
v_mfma_f32_16x16x32_bf16 v[70:73], v[176:179], a[16:19], v[70:73]
ds_read_b64_tr_b16 v[208:209], v64 offset:21568
ds_read_b64_tr_b16 v[210:211], v64 offset:25152
v_mfma_f32_16x16x32_bf16 v[98:101], v[176:179], a[20:23], v[98:101]
ds_read_b64_tr_b16 v[212:213], v64 offset:21600
ds_read_b64_tr_b16 v[214:215], v64 offset:25184
v_mfma_f32_16x16x32_bf16 v[74:77], v[180:183], a[16:19], v[74:77]
ds_read_b64_tr_b16 v[216:217], v64 offset:21632
ds_read_b64_tr_b16 v[218:219], v64 offset:25216
v_mfma_f32_16x16x32_bf16 v[102:105], v[180:183], a[20:23], v[102:105]
ds_read_b64_tr_b16 v[220:221], v64 offset:21664
ds_read_b64_tr_b16 v[222:223], v64 offset:25248
v_mfma_f32_16x16x32_bf16 v[78:81], v[184:187], a[16:19], v[78:81]
ds_read_b64_tr_b16 v[224:225], v64 offset:21696
ds_read_b64_tr_b16 v[226:227], v64 offset:25280
v_mfma_f32_16x16x32_bf16 v[106:109], v[184:187], a[20:23], v[106:109]
buffer_load_dwordx4 a[72:75], v7, s[44:47], s63 offen sc1
v_mfma_f32_16x16x32_bf16 v[82:85], v[188:191], a[16:19], v[82:85]
s_lshl_b32 s3, s6, 7
s_add_u32 s70, s70, s3
v_mfma_f32_16x16x32_bf16 v[110:113], v[188:191], a[20:23], v[110:113]
buffer_load_dwordx4 a[76:79], v7, s[44:47], s63 offen offset:256 sc1
s_add_u32 s63, s63, 131072
v_mfma_f32_16x16x32_bf16 v[86:89], v[192:195], a[16:19], v[86:89]
s_lshl_b32 s3, s78, 15
s_add_u32 s70, s70, s3
v_mfma_f32_16x16x32_bf16 v[114:117], v[192:195], a[20:23], v[114:117]
buffer_load_dwordx4 a[80:83], v7, s[44:47], s63 offen sc1
v_mfma_f32_16x16x32_bf16 v[90:93], v[196:199], a[16:19], v[90:93]
s_lshl_b32 s71, s4, 12
s_mul_i32 s66, s61, 458752
v_mfma_f32_16x16x32_bf16 v[118:121], v[196:199], a[20:23], v[118:121]
buffer_load_dwordx4 a[84:87], v7, s[44:47], s63 offen offset:256 sc1
s_add_u32 s63, s63, 131072
s_waitcnt vmcnt(14)
s_waitcnt lgkmcnt(0)
v_mfma_f32_16x16x32_bf16 v[66:69], v[200:203], a[24:27], v[66:69]
ds_read_b64_tr_b16 v[172:173], v64 offset:28672
ds_read_b64_tr_b16 v[174:175], v64 offset:32256
v_mfma_f32_16x16x32_bf16 v[94:97], v[200:203], a[28:31], v[94:97]
ds_read_b64_tr_b16 v[176:177], v64 offset:28704
ds_read_b64_tr_b16 v[178:179], v64 offset:32288
v_mfma_f32_16x16x32_bf16 v[70:73], v[204:207], a[24:27], v[70:73]
ds_read_b64_tr_b16 v[180:181], v64 offset:28736
ds_read_b64_tr_b16 v[182:183], v64 offset:32320
v_mfma_f32_16x16x32_bf16 v[98:101], v[204:207], a[28:31], v[98:101]
ds_read_b64_tr_b16 v[184:185], v64 offset:28768
ds_read_b64_tr_b16 v[186:187], v64 offset:32352
v_mfma_f32_16x16x32_bf16 v[74:77], v[208:211], a[24:27], v[74:77]
ds_read_b64_tr_b16 v[188:189], v64 offset:28800
ds_read_b64_tr_b16 v[190:191], v64 offset:32384
v_mfma_f32_16x16x32_bf16 v[102:105], v[208:211], a[28:31], v[102:105]
ds_read_b64_tr_b16 v[192:193], v64 offset:28832
ds_read_b64_tr_b16 v[194:195], v64 offset:32416
v_mfma_f32_16x16x32_bf16 v[78:81], v[212:215], a[24:27], v[78:81]
ds_read_b64_tr_b16 v[196:197], v64 offset:28864
ds_read_b64_tr_b16 v[198:199], v64 offset:32448
v_mfma_f32_16x16x32_bf16 v[106:109], v[212:215], a[28:31], v[106:109]
buffer_load_dwordx4 a[88:91], v7, s[44:47], s63 offen sc1
v_mfma_f32_16x16x32_bf16 v[82:85], v[216:219], a[24:27], v[82:85]
s_lshl_b32 s3, s60, 11
s_add_u32 s66, s66, s3
v_mfma_f32_16x16x32_bf16 v[110:113], v[216:219], a[28:31], v[110:113]
buffer_load_dwordx4 a[92:95], v7, s[44:47], s63 offen offset:256 sc1
s_add_u32 s63, s63, 131072
v_mfma_f32_16x16x32_bf16 v[86:89], v[220:223], a[24:27], v[86:89]
s_lshl_b32 s3, s4, 9
s_add_u32 s66, s66, s3
v_mfma_f32_16x16x32_bf16 v[114:117], v[220:223], a[28:31], v[114:117]
buffer_load_dwordx4 a[96:99], v7, s[44:47], s63 offen sc1
v_mfma_f32_16x16x32_bf16 v[90:93], v[224:227], a[24:27], v[90:93]
s_add_u32 s66, s66, 5242880
v_lshrrev_b32 v1, 1, v57
v_mfma_f32_16x16x32_bf16 v[118:121], v[224:227], a[28:31], v[118:121]
buffer_load_dwordx4 a[100:103], v7, s[44:47], s63 offen offset:256 sc1
s_add_u32 s63, s63, 131072
s_waitcnt vmcnt(16)
s_waitcnt lgkmcnt(0)
v_mfma_f32_16x16x32_bf16 v[66:69], v[172:175], a[32:35], v[66:69]
ds_read_b64_tr_b16 v[200:201], v64 offset:35840
ds_read_b64_tr_b16 v[202:203], v64 offset:39424
v_mfma_f32_16x16x32_bf16 v[94:97], v[172:175], a[36:39], v[94:97]
ds_read_b64_tr_b16 v[204:205], v64 offset:35872
ds_read_b64_tr_b16 v[206:207], v64 offset:39456
v_mfma_f32_16x16x32_bf16 v[70:73], v[176:179], a[32:35], v[70:73]
ds_read_b64_tr_b16 v[208:209], v64 offset:35904
ds_read_b64_tr_b16 v[210:211], v64 offset:39488
v_mfma_f32_16x16x32_bf16 v[98:101], v[176:179], a[36:39], v[98:101]
ds_read_b64_tr_b16 v[212:213], v64 offset:35936
ds_read_b64_tr_b16 v[214:215], v64 offset:39520
v_mfma_f32_16x16x32_bf16 v[74:77], v[180:183], a[32:35], v[74:77]
ds_read_b64_tr_b16 v[216:217], v64 offset:35968
ds_read_b64_tr_b16 v[218:219], v64 offset:39552
v_mfma_f32_16x16x32_bf16 v[102:105], v[180:183], a[36:39], v[102:105]
ds_read_b64_tr_b16 v[220:221], v64 offset:36000
ds_read_b64_tr_b16 v[222:223], v64 offset:39584
v_mfma_f32_16x16x32_bf16 v[78:81], v[184:187], a[32:35], v[78:81]
ds_read_b64_tr_b16 v[224:225], v64 offset:36032
ds_read_b64_tr_b16 v[226:227], v64 offset:39616
v_mfma_f32_16x16x32_bf16 v[106:109], v[184:187], a[36:39], v[106:109]
buffer_load_dwordx4 a[104:107], v7, s[44:47], s63 offen sc1
v_mfma_f32_16x16x32_bf16 v[82:85], v[188:191], a[32:35], v[82:85]
v_lshlrev_b32 v1, 15, v1
v_and_b32 v2, 31, v0
v_mfma_f32_16x16x32_bf16 v[110:113], v[188:191], a[36:39], v[110:113]
buffer_load_dwordx4 a[108:111], v7, s[44:47], s63 offen offset:256 sc1
s_add_u32 s63, s63, 131072
v_mfma_f32_16x16x32_bf16 v[86:89], v[192:195], a[32:35], v[86:89]
v_lshl_add_u32 v4, v2, 4, v1
v_lshlrev_b32 v3, 4, v57
v_mfma_f32_16x16x32_bf16 v[114:117], v[192:195], a[36:39], v[114:117]
buffer_load_dwordx4 a[112:115], v7, s[44:47], s63 offen sc1
v_mfma_f32_16x16x32_bf16 v[90:93], v[196:199], a[32:35], v[90:93]
v_add_u32 v3, 158848, v3
v_lshlrev_b32 v13, 10, v2
v_mfma_f32_16x16x32_bf16 v[118:121], v[196:199], a[36:39], v[118:121]
buffer_load_dwordx4 a[116:119], v7, s[44:47], s63 offen offset:256 sc1
s_add_u32 s63, s63, 131072
s_waitcnt vmcnt(18)
s_waitcnt lgkmcnt(0)
v_mfma_f32_16x16x32_bf16 v[66:69], v[200:203], a[40:43], v[66:69]
ds_read_b64_tr_b16 v[172:173], v64 offset:43008
ds_read_b64_tr_b16 v[174:175], v64 offset:46592
v_mfma_f32_16x16x32_bf16 v[94:97], v[200:203], a[44:47], v[94:97]
ds_read_b64_tr_b16 v[176:177], v64 offset:43040
ds_read_b64_tr_b16 v[178:179], v64 offset:46624
v_mfma_f32_16x16x32_bf16 v[70:73], v[204:207], a[40:43], v[70:73]
ds_read_b64_tr_b16 v[180:181], v64 offset:43072
ds_read_b64_tr_b16 v[182:183], v64 offset:46656
v_mfma_f32_16x16x32_bf16 v[98:101], v[204:207], a[44:47], v[98:101]
ds_read_b64_tr_b16 v[184:185], v64 offset:43104
ds_read_b64_tr_b16 v[186:187], v64 offset:46688
v_mfma_f32_16x16x32_bf16 v[74:77], v[208:211], a[40:43], v[74:77]
ds_read_b64_tr_b16 v[188:189], v64 offset:43136
ds_read_b64_tr_b16 v[190:191], v64 offset:46720
v_mfma_f32_16x16x32_bf16 v[102:105], v[208:211], a[44:47], v[102:105]
ds_read_b64_tr_b16 v[192:193], v64 offset:43168
ds_read_b64_tr_b16 v[194:195], v64 offset:46752
v_mfma_f32_16x16x32_bf16 v[78:81], v[212:215], a[40:43], v[78:81]
ds_read_b64_tr_b16 v[196:197], v64 offset:43200
ds_read_b64_tr_b16 v[198:199], v64 offset:46784
v_mfma_f32_16x16x32_bf16 v[106:109], v[212:215], a[44:47], v[106:109]
buffer_load_dwordx4 a[120:123], v7, s[44:47], s63 offen sc1
v_mfma_f32_16x16x32_bf16 v[82:85], v[216:219], a[40:43], v[82:85]
v_lshrrev_b32 v1, 5, v58
v_mul_u32_u24 v1, 917504, v1
v_mfma_f32_16x16x32_bf16 v[110:113], v[216:219], a[44:47], v[110:113]
buffer_load_dwordx4 a[124:127], v7, s[44:47], s63 offen offset:256 sc1
s_add_u32 s63, s63, 131072
v_mfma_f32_16x16x32_bf16 v[86:89], v[220:223], a[40:43], v[86:89]
v_add_u32 v13, v13, v1
s_and_b32 s69, s5, 3
v_mfma_f32_16x16x32_bf16 v[114:117], v[220:223], a[44:47], v[114:117]
buffer_load_dword v236, v5, s[44:47], s64 offen offset:0 sc1
v_mfma_f32_16x16x32_bf16 v[90:93], v[224:227], a[40:43], v[90:93]
s_lshl_b32 s69, s69, 2
s_add_u32 s69, s69, s4
v_mfma_f32_16x16x32_bf16 v[118:121], v[224:227], a[44:47], v[118:121]
buffer_load_dword v237, v5, s[44:47], s64 offen offset:64 sc1
s_waitcnt vmcnt(20)
s_waitcnt lgkmcnt(0)
v_mfma_f32_16x16x32_bf16 v[66:69], v[172:175], a[48:51], v[66:69]
ds_read_b64_tr_b16 v[200:201], v64 offset:50176
ds_read_b64_tr_b16 v[202:203], v64 offset:53760
v_mfma_f32_16x16x32_bf16 v[94:97], v[172:175], a[52:55], v[94:97]
ds_read_b64_tr_b16 v[204:205], v64 offset:50208
ds_read_b64_tr_b16 v[206:207], v64 offset:53792
v_mfma_f32_16x16x32_bf16 v[70:73], v[176:179], a[48:51], v[70:73]
ds_read_b64_tr_b16 v[208:209], v64 offset:50240
ds_read_b64_tr_b16 v[210:211], v64 offset:53824
v_mfma_f32_16x16x32_bf16 v[98:101], v[176:179], a[52:55], v[98:101]
ds_read_b64_tr_b16 v[212:213], v64 offset:50272
ds_read_b64_tr_b16 v[214:215], v64 offset:53856
v_mfma_f32_16x16x32_bf16 v[74:77], v[180:183], a[48:51], v[74:77]
ds_read_b64_tr_b16 v[216:217], v64 offset:50304
ds_read_b64_tr_b16 v[218:219], v64 offset:53888
v_mfma_f32_16x16x32_bf16 v[102:105], v[180:183], a[52:55], v[102:105]
ds_read_b64_tr_b16 v[220:221], v64 offset:50336
ds_read_b64_tr_b16 v[222:223], v64 offset:53920
v_mfma_f32_16x16x32_bf16 v[78:81], v[184:187], a[48:51], v[78:81]
ds_read_b64_tr_b16 v[224:225], v64 offset:50368
ds_read_b64_tr_b16 v[226:227], v64 offset:53952
v_mfma_f32_16x16x32_bf16 v[106:109], v[184:187], a[52:55], v[106:109]
buffer_load_dword v238, v6, s[44:47], s64 offen offset:0 sc1
v_mfma_f32_16x16x32_bf16 v[82:85], v[188:191], a[48:51], v[82:85]
s_add_u32 s69, s69, 12
s_lshl_b32 s69, s69, 15
v_mfma_f32_16x16x32_bf16 v[110:113], v[188:191], a[52:55], v[110:113]
buffer_load_dword v239, v6, s[44:47], s64 offen offset:64 sc1
v_mfma_f32_16x16x32_bf16 v[86:89], v[192:195], a[48:51], v[86:89]
s_lshl_b32 s3, s6, 7
s_add_u32 s69, s69, s3
v_mfma_f32_16x16x32_bf16 v[114:117], v[192:195], a[52:55], v[114:117]
buffer_load_dword v240, v5, s[44:47], s64 offen offset:128 sc1
v_mfma_f32_16x16x32_bf16 v[90:93], v[196:199], a[48:51], v[90:93]
v_mfma_f32_16x16x32_bf16 v[118:121], v[196:199], a[52:55], v[118:121]
buffer_load_dword v241, v5, s[44:47], s64 offen offset:192 sc1
s_waitcnt vmcnt(22)
s_waitcnt lgkmcnt(0)
v_mfma_f32_16x16x32_bf16 v[66:69], v[200:203], a[56:59], v[66:69]
ds_read_b64_tr_b16 v[172:173], v65 offset:0
ds_read_b64_tr_b16 v[174:175], v65 offset:3584
v_mfma_f32_16x16x32_bf16 v[94:97], v[200:203], a[60:63], v[94:97]
ds_read_b64_tr_b16 v[176:177], v65 offset:32
ds_read_b64_tr_b16 v[178:179], v65 offset:3616
v_mfma_f32_16x16x32_bf16 v[70:73], v[204:207], a[56:59], v[70:73]
ds_read_b64_tr_b16 v[180:181], v65 offset:64
ds_read_b64_tr_b16 v[182:183], v65 offset:3648
v_mfma_f32_16x16x32_bf16 v[98:101], v[204:207], a[60:63], v[98:101]
ds_read_b64_tr_b16 v[184:185], v65 offset:96
ds_read_b64_tr_b16 v[186:187], v65 offset:3680
v_mfma_f32_16x16x32_bf16 v[74:77], v[208:211], a[56:59], v[74:77]
ds_read_b64_tr_b16 v[188:189], v65 offset:128
ds_read_b64_tr_b16 v[190:191], v65 offset:3712
v_mfma_f32_16x16x32_bf16 v[102:105], v[208:211], a[60:63], v[102:105]
ds_read_b64_tr_b16 v[192:193], v65 offset:160
ds_read_b64_tr_b16 v[194:195], v65 offset:3744
v_mfma_f32_16x16x32_bf16 v[78:81], v[212:215], a[56:59], v[78:81]
ds_read_b64_tr_b16 v[196:197], v65 offset:192
ds_read_b64_tr_b16 v[198:199], v65 offset:3776
v_mfma_f32_16x16x32_bf16 v[106:109], v[212:215], a[60:63], v[106:109]
buffer_load_dword v242, v6, s[44:47], s64 offen offset:128 sc1
v_mfma_f32_16x16x32_bf16 v[82:85], v[216:219], a[56:59], v[82:85]
v_mfma_f32_16x16x32_bf16 v[110:113], v[216:219], a[60:63], v[110:113]
buffer_load_dword v243, v6, s[44:47], s64 offen offset:192 sc1
v_mfma_f32_16x16x32_bf16 v[86:89], v[220:223], a[56:59], v[86:89]
v_mfma_f32_16x16x32_bf16 v[114:117], v[220:223], a[60:63], v[114:117]
v_mfma_f32_16x16x32_bf16 v[90:93], v[224:227], a[56:59], v[90:93]
v_mfma_f32_16x16x32_bf16 v[118:121], v[224:227], a[60:63], v[118:121]
s_waitcnt vmcnt(22)
s_waitcnt lgkmcnt(0)
s_barrier
v_mfma_f32_16x16x32_bf16 v[66:69], v[172:175], a[64:67], v[66:69]
ds_read_b64_tr_b16 v[200:201], v65 offset:7168
ds_read_b64_tr_b16 v[202:203], v65 offset:10752
v_mfma_f32_16x16x32_bf16 v[94:97], v[172:175], a[68:71], v[94:97]
ds_read_b64_tr_b16 v[204:205], v65 offset:7200
ds_read_b64_tr_b16 v[206:207], v65 offset:10784
v_mfma_f32_16x16x32_bf16 v[70:73], v[176:179], a[64:67], v[70:73]
ds_read_b64_tr_b16 v[208:209], v65 offset:7232
ds_read_b64_tr_b16 v[210:211], v65 offset:10816
v_mfma_f32_16x16x32_bf16 v[98:101], v[176:179], a[68:71], v[98:101]
ds_read_b64_tr_b16 v[212:213], v65 offset:7264
ds_read_b64_tr_b16 v[214:215], v65 offset:10848
v_mfma_f32_16x16x32_bf16 v[74:77], v[180:183], a[64:67], v[74:77]
ds_read_b64_tr_b16 v[216:217], v65 offset:7296
ds_read_b64_tr_b16 v[218:219], v65 offset:10880
v_mfma_f32_16x16x32_bf16 v[102:105], v[180:183], a[68:71], v[102:105]
ds_read_b64_tr_b16 v[220:221], v65 offset:7328
ds_read_b64_tr_b16 v[222:223], v65 offset:10912
v_mfma_f32_16x16x32_bf16 v[78:81], v[184:187], a[64:67], v[78:81]
ds_read_b64_tr_b16 v[224:225], v65 offset:7360
ds_read_b64_tr_b16 v[226:227], v65 offset:10944
v_mfma_f32_16x16x32_bf16 v[106:109], v[184:187], a[68:71], v[106:109]
s_add_u32 s72, s70, 0
s_add_u32 m0, s71, 0
v_mfma_f32_16x16x32_bf16 v[82:85], v[188:191], a[64:67], v[82:85]
v_mfma_f32_16x16x32_bf16 v[110:113], v[188:191], a[68:71], v[110:113]
buffer_load_dwordx4 v8, s[32:35], s72 offen offset:0 lds
v_mfma_f32_16x16x32_bf16 v[86:89], v[192:195], a[64:67], v[86:89]
v_mfma_f32_16x16x32_bf16 v[114:117], v[192:195], a[68:71], v[114:117]
buffer_load_dwordx4 v9, s[32:35], s72 offen offset:1024 lds
v_mfma_f32_16x16x32_bf16 v[90:93], v[196:199], a[64:67], v[90:93]
v_mfma_f32_16x16x32_bf16 v[118:121], v[196:199], a[68:71], v[118:121]
buffer_load_dwordx4 v10, s[32:35], s72 offen offset:2048 lds
s_waitcnt vmcnt(23)
s_waitcnt lgkmcnt(0)
v_mfma_f32_16x16x32_bf16 v[66:69], v[200:203], a[72:75], v[66:69]
ds_read_b64_tr_b16 v[172:173], v65 offset:14336
ds_read_b64_tr_b16 v[174:175], v65 offset:17920
v_mfma_f32_16x16x32_bf16 v[94:97], v[200:203], a[76:79], v[94:97]
ds_read_b64_tr_b16 v[176:177], v65 offset:14368
ds_read_b64_tr_b16 v[178:179], v65 offset:17952
v_mfma_f32_16x16x32_bf16 v[70:73], v[204:207], a[72:75], v[70:73]
ds_read_b64_tr_b16 v[180:181], v65 offset:14400
ds_read_b64_tr_b16 v[182:183], v65 offset:17984
v_mfma_f32_16x16x32_bf16 v[98:101], v[204:207], a[76:79], v[98:101]
ds_read_b64_tr_b16 v[184:185], v65 offset:14432
ds_read_b64_tr_b16 v[186:187], v65 offset:18016
v_mfma_f32_16x16x32_bf16 v[74:77], v[208:211], a[72:75], v[74:77]
ds_read_b64_tr_b16 v[188:189], v65 offset:14464
ds_read_b64_tr_b16 v[190:191], v65 offset:18048
v_mfma_f32_16x16x32_bf16 v[102:105], v[208:211], a[76:79], v[102:105]
ds_read_b64_tr_b16 v[192:193], v65 offset:14496
ds_read_b64_tr_b16 v[194:195], v65 offset:18080
v_mfma_f32_16x16x32_bf16 v[78:81], v[212:215], a[72:75], v[78:81]
ds_read_b64_tr_b16 v[196:197], v65 offset:14528
ds_read_b64_tr_b16 v[198:199], v65 offset:18112
v_mfma_f32_16x16x32_bf16 v[106:109], v[212:215], a[76:79], v[106:109]
buffer_load_dwordx4 v11, s[32:35], s72 offen offset:3072 lds
v_mfma_f32_16x16x32_bf16 v[82:85], v[216:219], a[72:75], v[82:85]
v_mfma_f32_16x16x32_bf16 v[110:113], v[216:219], a[76:79], v[110:113]
s_add_u32 s72, s70, 65536
s_add_u32 m0, s71, 16384
v_mfma_f32_16x16x32_bf16 v[86:89], v[220:223], a[72:75], v[86:89]
v_mfma_f32_16x16x32_bf16 v[114:117], v[220:223], a[76:79], v[114:117]
buffer_load_dwordx4 v8, s[32:35], s72 offen offset:0 lds
v_mfma_f32_16x16x32_bf16 v[90:93], v[224:227], a[72:75], v[90:93]
v_mfma_f32_16x16x32_bf16 v[118:121], v[224:227], a[76:79], v[118:121]
buffer_load_dwordx4 v9, s[32:35], s72 offen offset:1024 lds
s_waitcnt vmcnt(24)
s_waitcnt lgkmcnt(0)
v_mfma_f32_16x16x32_bf16 v[66:69], v[172:175], a[80:83], v[66:69]
ds_read_b64_tr_b16 v[200:201], v65 offset:21504
ds_read_b64_tr_b16 v[202:203], v65 offset:25088
v_mfma_f32_16x16x32_bf16 v[94:97], v[172:175], a[84:87], v[94:97]
ds_read_b64_tr_b16 v[204:205], v65 offset:21536
ds_read_b64_tr_b16 v[206:207], v65 offset:25120
v_mfma_f32_16x16x32_bf16 v[70:73], v[176:179], a[80:83], v[70:73]
ds_read_b64_tr_b16 v[208:209], v65 offset:21568
ds_read_b64_tr_b16 v[210:211], v65 offset:25152
v_mfma_f32_16x16x32_bf16 v[98:101], v[176:179], a[84:87], v[98:101]
ds_read_b64_tr_b16 v[212:213], v65 offset:21600
ds_read_b64_tr_b16 v[214:215], v65 offset:25184
v_mfma_f32_16x16x32_bf16 v[74:77], v[180:183], a[80:83], v[74:77]
ds_read_b64_tr_b16 v[216:217], v65 offset:21632
ds_read_b64_tr_b16 v[218:219], v65 offset:25216
v_mfma_f32_16x16x32_bf16 v[102:105], v[180:183], a[84:87], v[102:105]
ds_read_b64_tr_b16 v[220:221], v65 offset:21664
ds_read_b64_tr_b16 v[222:223], v65 offset:25248
v_mfma_f32_16x16x32_bf16 v[78:81], v[184:187], a[80:83], v[78:81]
ds_read_b64_tr_b16 v[224:225], v65 offset:21696
ds_read_b64_tr_b16 v[226:227], v65 offset:25280
v_mfma_f32_16x16x32_bf16 v[106:109], v[184:187], a[84:87], v[106:109]
buffer_load_dwordx4 v10, s[32:35], s72 offen offset:2048 lds
v_mfma_f32_16x16x32_bf16 v[82:85], v[188:191], a[80:83], v[82:85]
s_waitcnt vmcnt(12)
v_add_f32 v236, v236, v238
s_waitcnt vmcnt(11)
v_add_f32 v237, v237, v239
v_mfma_f32_16x16x32_bf16 v[110:113], v[188:191], a[84:87], v[110:113]
buffer_load_dwordx4 v11, s[32:35], s72 offen offset:3072 lds
v_mfma_f32_16x16x32_bf16 v[86:89], v[192:195], a[80:83], v[86:89]
s_nop 0
v_permlane32_swap_b32 v236, v237
v_mfma_f32_16x16x32_bf16 v[114:117], v[192:195], a[84:87], v[114:117]
s_add_u32 s72, s70, 131072
s_add_u32 m0, s71, 32768
v_mfma_f32_16x16x32_bf16 v[90:93], v[196:199], a[80:83], v[90:93]
v_add_f32 v236, v236, v237
v_mov_b32 v238, v236
v_mfma_f32_16x16x32_bf16 v[118:121], v[196:199], a[84:87], v[118:121]
buffer_load_dwordx4 v8, s[32:35], s72 offen offset:0 lds
s_waitcnt lgkmcnt(0)
v_mfma_f32_16x16x32_bf16 v[66:69], v[200:203], a[88:91], v[66:69]
ds_read_b64_tr_b16 v[172:173], v65 offset:28672
ds_read_b64_tr_b16 v[174:175], v65 offset:32256
v_mfma_f32_16x16x32_bf16 v[94:97], v[200:203], a[92:95], v[94:97]
ds_read_b64_tr_b16 v[176:177], v65 offset:28704
ds_read_b64_tr_b16 v[178:179], v65 offset:32288
v_mfma_f32_16x16x32_bf16 v[70:73], v[204:207], a[88:91], v[70:73]
ds_read_b64_tr_b16 v[180:181], v65 offset:28736
ds_read_b64_tr_b16 v[182:183], v65 offset:32320
v_mfma_f32_16x16x32_bf16 v[98:101], v[204:207], a[92:95], v[98:101]
ds_read_b64_tr_b16 v[184:185], v65 offset:28768
ds_read_b64_tr_b16 v[186:187], v65 offset:32352
v_mfma_f32_16x16x32_bf16 v[74:77], v[208:211], a[88:91], v[74:77]
ds_read_b64_tr_b16 v[188:189], v65 offset:28800
ds_read_b64_tr_b16 v[190:191], v65 offset:32384
v_mfma_f32_16x16x32_bf16 v[102:105], v[208:211], a[92:95], v[102:105]
ds_read_b64_tr_b16 v[192:193], v65 offset:28832
ds_read_b64_tr_b16 v[194:195], v65 offset:32416
v_mfma_f32_16x16x32_bf16 v[78:81], v[212:215], a[88:91], v[78:81]
ds_read_b64_tr_b16 v[196:197], v65 offset:28864
ds_read_b64_tr_b16 v[198:199], v65 offset:32448
v_mfma_f32_16x16x32_bf16 v[106:109], v[212:215], a[92:95], v[106:109]
buffer_load_dwordx4 v9, s[32:35], s72 offen offset:1024 lds
v_mfma_f32_16x16x32_bf16 v[82:85], v[216:219], a[88:91], v[82:85]
v_permlane16_swap_b32 v236, v238
v_add_f32 v236, v236, v238
v_mfma_f32_16x16x32_bf16 v[110:113], v[216:219], a[92:95], v[110:113]
buffer_load_dwordx4 v10, s[32:35], s72 offen offset:2048 lds
v_mfma_f32_16x16x32_bf16 v[86:89], v[220:223], a[88:91], v[86:89]
v_mov_b32 v237, v236
v_mov_b32 v239, 0x3b000000
v_mfma_f32_16x16x32_bf16 v[114:117], v[220:223], a[92:95], v[114:117]
buffer_load_dwordx4 v11, s[32:35], s72 offen offset:3072 lds
v_mfma_f32_16x16x32_bf16 v[90:93], v[224:227], a[88:91], v[90:93]
v_permlane32_swap_b32 v236, v237
v_mul_f32 v236, v239, v236
v_mfma_f32_16x16x32_bf16 v[118:121], v[224:227], a[92:95], v[118:121]
s_add_u32 s72, s70, 196608
s_add_u32 m0, s71, 49152
s_waitcnt lgkmcnt(0)
v_mfma_f32_16x16x32_bf16 v[66:69], v[172:175], a[96:99], v[66:69]
ds_read_b64_tr_b16 v[200:201], v65 offset:35840
ds_read_b64_tr_b16 v[202:203], v65 offset:39424
v_mfma_f32_16x16x32_bf16 v[94:97], v[172:175], a[100:103], v[94:97]
ds_read_b64_tr_b16 v[204:205], v65 offset:35872
ds_read_b64_tr_b16 v[206:207], v65 offset:39456
v_mfma_f32_16x16x32_bf16 v[70:73], v[176:179], a[96:99], v[70:73]
ds_read_b64_tr_b16 v[208:209], v65 offset:35904
ds_read_b64_tr_b16 v[210:211], v65 offset:39488
v_mfma_f32_16x16x32_bf16 v[98:101], v[176:179], a[100:103], v[98:101]
ds_read_b64_tr_b16 v[212:213], v65 offset:35936
ds_read_b64_tr_b16 v[214:215], v65 offset:39520
v_mfma_f32_16x16x32_bf16 v[74:77], v[180:183], a[96:99], v[74:77]
ds_read_b64_tr_b16 v[216:217], v65 offset:35968
ds_read_b64_tr_b16 v[218:219], v65 offset:39552
v_mfma_f32_16x16x32_bf16 v[102:105], v[180:183], a[100:103], v[102:105]
ds_read_b64_tr_b16 v[220:221], v65 offset:36000
ds_read_b64_tr_b16 v[222:223], v65 offset:39584
v_mfma_f32_16x16x32_bf16 v[78:81], v[184:187], a[96:99], v[78:81]
ds_read_b64_tr_b16 v[224:225], v65 offset:36032
ds_read_b64_tr_b16 v[226:227], v65 offset:39616
v_mfma_f32_16x16x32_bf16 v[106:109], v[184:187], a[100:103], v[106:109]
buffer_load_dwordx4 v8, s[32:35], s72 offen offset:0 lds
v_mfma_f32_16x16x32_bf16 v[82:85], v[188:191], a[96:99], v[82:85]
v_mul_f32 v238, v236, v236
v_fma_f32 v237, v237, v239, -v238
v_mfma_f32_16x16x32_bf16 v[110:113], v[188:191], a[100:103], v[110:113]
buffer_load_dwordx4 v9, s[32:35], s72 offen offset:1024 lds
v_mfma_f32_16x16x32_bf16 v[86:89], v[192:195], a[96:99], v[86:89]
v_max_f32 v237, 0, v237
v_add_f32 v237, 0x3727c5ac, v237
v_mfma_f32_16x16x32_bf16 v[114:117], v[192:195], a[100:103], v[114:117]
buffer_load_dwordx4 v10, s[32:35], s72 offen offset:2048 lds
v_mfma_f32_16x16x32_bf16 v[90:93], v[196:199], a[96:99], v[90:93]
v_rsq_f32 v237, v237
v_rcp_f32 v234, v237
v_mfma_f32_16x16x32_bf16 v[118:121], v[196:199], a[100:103], v[118:121]
buffer_load_dwordx4 v11, s[32:35], s72 offen offset:3072 lds
s_waitcnt lgkmcnt(0)
v_mfma_f32_16x16x32_bf16 v[66:69], v[200:203], a[104:107], v[66:69]
ds_read_b64_tr_b16 v[172:173], v65 offset:43008
ds_read_b64_tr_b16 v[174:175], v65 offset:46592
v_mfma_f32_16x16x32_bf16 v[94:97], v[200:203], a[108:111], v[94:97]
ds_read_b64_tr_b16 v[176:177], v65 offset:43040
ds_read_b64_tr_b16 v[178:179], v65 offset:46624
v_mfma_f32_16x16x32_bf16 v[70:73], v[204:207], a[104:107], v[70:73]
ds_read_b64_tr_b16 v[180:181], v65 offset:43072
ds_read_b64_tr_b16 v[182:183], v65 offset:46656
v_mfma_f32_16x16x32_bf16 v[98:101], v[204:207], a[108:111], v[98:101]
ds_read_b64_tr_b16 v[184:185], v65 offset:43104
ds_read_b64_tr_b16 v[186:187], v65 offset:46688
v_mfma_f32_16x16x32_bf16 v[74:77], v[208:211], a[104:107], v[74:77]
ds_read_b64_tr_b16 v[188:189], v65 offset:43136
ds_read_b64_tr_b16 v[190:191], v65 offset:46720
v_mfma_f32_16x16x32_bf16 v[102:105], v[208:211], a[108:111], v[102:105]
ds_read_b64_tr_b16 v[192:193], v65 offset:43168
ds_read_b64_tr_b16 v[194:195], v65 offset:46752
v_mfma_f32_16x16x32_bf16 v[78:81], v[212:215], a[104:107], v[78:81]
ds_read_b64_tr_b16 v[196:197], v65 offset:43200
ds_read_b64_tr_b16 v[198:199], v65 offset:46784
v_mfma_f32_16x16x32_bf16 v[106:109], v[212:215], a[108:111], v[106:109]
buffer_load_dword v255, v13, s[32:35], s69 offen
v_mfma_f32_16x16x32_bf16 v[82:85], v[216:219], a[104:107], v[82:85]
v_sub_f32 v228, 0, v236
v_mul_f32 v230, 0xc0135761, v237
v_mfma_f32_16x16x32_bf16 v[110:113], v[216:219], a[108:111], v[110:113]
v_mul_f32 v232, v237, v237
v_mov_b32 v229, v228
v_mfma_f32_16x16x32_bf16 v[86:89], v[220:223], a[104:107], v[86:89]
v_mul_f32 v232, v232, v230
v_mov_b32 v231, v230
v_mfma_f32_16x16x32_bf16 v[114:117], v[220:223], a[108:111], v[114:117]
v_mov_b32 v235, v234
v_mul_f32 v232, 0x3d372713, v232
v_mfma_f32_16x16x32_bf16 v[90:93], v[224:227], a[104:107], v[90:93]
v_mov_b32 v233, v232
s_waitcnt vmcnt(18)
v_add_f32 v240, v240, v242
v_mfma_f32_16x16x32_bf16 v[118:121], v[224:227], a[108:111], v[118:121]
s_waitcnt vmcnt(17)
v_add_f32 v241, v241, v243
s_nop 0
s_waitcnt lgkmcnt(0)
v_mfma_f32_16x16x32_bf16 v[66:69], v[172:175], a[112:115], v[66:69]
ds_read_b64_tr_b16 v[200:201], v65 offset:50176
ds_read_b64_tr_b16 v[202:203], v65 offset:53760
v_mfma_f32_16x16x32_bf16 v[94:97], v[172:175], a[116:119], v[94:97]
ds_read_b64_tr_b16 v[204:205], v65 offset:50208
ds_read_b64_tr_b16 v[206:207], v65 offset:53792
v_mfma_f32_16x16x32_bf16 v[70:73], v[176:179], a[112:115], v[70:73]
ds_read_b64_tr_b16 v[208:209], v65 offset:50240
ds_read_b64_tr_b16 v[210:211], v65 offset:53824
v_mfma_f32_16x16x32_bf16 v[98:101], v[176:179], a[116:119], v[98:101]
ds_read_b64_tr_b16 v[212:213], v65 offset:50272
ds_read_b64_tr_b16 v[214:215], v65 offset:53856
v_mfma_f32_16x16x32_bf16 v[74:77], v[180:183], a[112:115], v[74:77]
ds_read_b64_tr_b16 v[216:217], v65 offset:50304
ds_read_b64_tr_b16 v[218:219], v65 offset:53888
v_mfma_f32_16x16x32_bf16 v[102:105], v[180:183], a[116:119], v[102:105]
ds_read_b64_tr_b16 v[220:221], v65 offset:50336
ds_read_b64_tr_b16 v[222:223], v65 offset:53920
v_mfma_f32_16x16x32_bf16 v[78:81], v[184:187], a[112:115], v[78:81]
ds_read_b64_tr_b16 v[224:225], v65 offset:50368
ds_read_b64_tr_b16 v[226:227], v65 offset:53952
v_mfma_f32_16x16x32_bf16 v[106:109], v[184:187], a[116:119], v[106:109]
v_permlane32_swap_b32 v240, v241
v_add_f32 v240, v240, v241
v_mfma_f32_16x16x32_bf16 v[82:85], v[188:191], a[112:115], v[82:85]
v_mov_b32 v242, v240
s_nop 1
v_permlane16_swap_b32 v240, v242
v_mfma_f32_16x16x32_bf16 v[110:113], v[188:191], a[116:119], v[110:113]
v_add_f32 v240, v240, v242
v_mov_b32 v241, v240
v_mfma_f32_16x16x32_bf16 v[86:89], v[192:195], a[112:115], v[86:89]
v_mov_b32 v243, 0x3b000000
v_permlane32_swap_b32 v240, v241
v_mfma_f32_16x16x32_bf16 v[114:117], v[192:195], a[116:119], v[114:117]
v_mul_f32 v240, v243, v240
v_mul_f32 v242, v240, v240
v_mfma_f32_16x16x32_bf16 v[90:93], v[196:199], a[112:115], v[90:93]
v_fma_f32 v241, v241, v243, -v242
v_max_f32 v241, 0, v241
v_mfma_f32_16x16x32_bf16 v[118:121], v[196:199], a[116:119], v[118:121]
v_add_f32 v241, 0x3727c5ac, v241
v_rsq_f32 v241, v241
s_waitcnt lgkmcnt(0)
v_mfma_f32_16x16x32_bf16 v[66:69], v[200:203], a[120:123], v[66:69]
ds_read_b128 v[140:143], v3 offset:0
ds_read_b128 v[144:147], v3 offset:64
v_mfma_f32_16x16x32_bf16 v[94:97], v[200:203], a[124:127], v[94:97]
ds_read_b128 v[148:151], v3 offset:128
ds_read_b128 v[152:155], v3 offset:192
v_mfma_f32_16x16x32_bf16 v[70:73], v[204:207], a[120:123], v[70:73]
ds_read_b128 v[156:159], v3 offset:256
ds_read_b128 v[160:163], v3 offset:320
v_mfma_f32_16x16x32_bf16 v[98:101], v[204:207], a[124:127], v[98:101]
ds_read_b128 v[164:167], v3 offset:384
v_mfma_f32_16x16x32_bf16 v[74:77], v[208:211], a[120:123], v[74:77]
v_mfma_f32_16x16x32_bf16 v[102:105], v[208:211], a[124:127], v[102:105]
v_mfma_f32_16x16x32_bf16 v[78:81], v[212:215], a[120:123], v[78:81]
v_mfma_f32_16x16x32_bf16 v[106:109], v[212:215], a[124:127], v[106:109]
v_rcp_f32 v130, v241
v_sub_f32 v124, 0, v240
v_mfma_f32_16x16x32_bf16 v[82:85], v[216:219], a[120:123], v[82:85]
v_mul_f32 v126, 0xc0135761, v241
v_mul_f32 v128, v241, v241
v_mfma_f32_16x16x32_bf16 v[110:113], v[216:219], a[124:127], v[110:113]
v_mov_b32 v125, v124
v_mul_f32 v128, v128, v126
v_mfma_f32_16x16x32_bf16 v[86:89], v[220:223], a[120:123], v[86:89]
v_mov_b32 v127, v126
v_mov_b32 v131, v130
v_mfma_f32_16x16x32_bf16 v[114:117], v[220:223], a[124:127], v[114:117]
v_mul_f32 v128, 0x3d372713, v128
v_mov_b32 v129, v128
v_mfma_f32_16x16x32_bf16 v[90:93], v[224:227], a[120:123], v[90:93]
v_mfma_f32_16x16x32_bf16 v[118:121], v[224:227], a[124:127], v[118:121]
s_waitcnt lgkmcnt(6)
v_pk_fma_f32 v[172:173], v[140:141], v[228:229], v[66:67]
v_pk_fma_f32 v[176:177], v[142:143], v[228:229], v[68:69]
v_pk_fma_f32 v[180:181], v[140:141], v[124:125], v[94:95]
v_pk_fma_f32 v[184:185], v[142:143], v[124:125], v[96:97]
v_pk_mul_f32 v[174:175], v[172:173], v[172:173]
v_pk_mul_f32 v[178:179], v[176:177], v[176:177]
v_pk_mul_f32 v[182:183], v[180:181], v[180:181]
v_pk_mul_f32 v[186:187], v[184:185], v[184:185]
v_pk_fma_f32 v[174:175], v[174:175], v[232:233], v[230:231]
v_pk_fma_f32 v[178:179], v[178:179], v[232:233], v[230:231]
v_pk_fma_f32 v[182:183], v[182:183], v[128:129], v[126:127]
v_pk_fma_f32 v[186:187], v[186:187], v[128:129], v[126:127]
v_pk_mul_f32 v[174:175], v[174:175], v[172:173]
v_pk_mul_f32 v[178:179], v[178:179], v[176:177]
v_pk_mul_f32 v[182:183], v[182:183], v[180:181]
v_pk_mul_f32 v[186:187], v[186:187], v[184:185]
v_exp_f32 v174, v174
v_exp_f32 v175, v175
v_exp_f32 v178, v178
v_exp_f32 v179, v179
v_exp_f32 v182, v182
v_exp_f32 v183, v183
v_exp_f32 v186, v186
v_exp_f32 v187, v187
v_pk_fma_f32 v[174:175], v[174:175], v[234:235], v[234:235]
v_pk_fma_f32 v[178:179], v[178:179], v[234:235], v[234:235]
v_pk_fma_f32 v[182:183], v[182:183], v[130:131], v[130:131]
v_pk_fma_f32 v[186:187], v[186:187], v[130:131], v[130:131]
v_rcp_f32 v174, v174
v_rcp_f32 v175, v175
v_rcp_f32 v178, v178
v_rcp_f32 v179, v179
v_rcp_f32 v182, v182
v_rcp_f32 v183, v183
v_rcp_f32 v186, v186
v_rcp_f32 v187, v187
v_pk_mul_f32 v[172:173], v[172:173], v[174:175]
v_pk_mul_f32 v[176:177], v[176:177], v[178:179]
v_pk_mul_f32 v[180:181], v[180:181], v[182:183]
v_pk_mul_f32 v[184:185], v[184:185], v[186:187]
v_cvt_pk_bf16_f32 v188, v172, v173
v_cvt_pk_bf16_f32 v189, v176, v177
v_cvt_pk_bf16_f32 v190, v180, v181
v_cvt_pk_bf16_f32 v191, v184, v185
s_nop 0
v_permlane16_swap_b32 v188, v190
s_nop 0
v_permlane16_swap_b32 v189, v191
buffer_store_dwordx4 v[188:191], v4, s[44:47], s66 offen sc1
s_add_u32 s66, s66, 65536
s_waitcnt lgkmcnt(5)
v_pk_fma_f32 v[172:173], v[144:145], v[228:229], v[70:71]
v_pk_fma_f32 v[176:177], v[146:147], v[228:229], v[72:73]
v_pk_fma_f32 v[180:181], v[144:145], v[124:125], v[98:99]
v_pk_fma_f32 v[184:185], v[146:147], v[124:125], v[100:101]
v_pk_mul_f32 v[174:175], v[172:173], v[172:173]
v_pk_mul_f32 v[178:179], v[176:177], v[176:177]
v_pk_mul_f32 v[182:183], v[180:181], v[180:181]
v_pk_mul_f32 v[186:187], v[184:185], v[184:185]
v_pk_fma_f32 v[174:175], v[174:175], v[232:233], v[230:231]
v_pk_fma_f32 v[178:179], v[178:179], v[232:233], v[230:231]
v_pk_fma_f32 v[182:183], v[182:183], v[128:129], v[126:127]
v_pk_fma_f32 v[186:187], v[186:187], v[128:129], v[126:127]
v_pk_mul_f32 v[174:175], v[174:175], v[172:173]
v_pk_mul_f32 v[178:179], v[178:179], v[176:177]
v_pk_mul_f32 v[182:183], v[182:183], v[180:181]
v_pk_mul_f32 v[186:187], v[186:187], v[184:185]
v_exp_f32 v174, v174
v_exp_f32 v175, v175
v_exp_f32 v178, v178
v_exp_f32 v179, v179
v_exp_f32 v182, v182
v_exp_f32 v183, v183
v_exp_f32 v186, v186
v_exp_f32 v187, v187
v_pk_fma_f32 v[174:175], v[174:175], v[234:235], v[234:235]
v_pk_fma_f32 v[178:179], v[178:179], v[234:235], v[234:235]
v_pk_fma_f32 v[182:183], v[182:183], v[130:131], v[130:131]
v_pk_fma_f32 v[186:187], v[186:187], v[130:131], v[130:131]
v_rcp_f32 v174, v174
v_rcp_f32 v175, v175
v_rcp_f32 v178, v178
v_rcp_f32 v179, v179
v_rcp_f32 v182, v182
v_rcp_f32 v183, v183
v_rcp_f32 v186, v186
v_rcp_f32 v187, v187
v_pk_mul_f32 v[172:173], v[172:173], v[174:175]
v_pk_mul_f32 v[176:177], v[176:177], v[178:179]
v_pk_mul_f32 v[180:181], v[180:181], v[182:183]
v_pk_mul_f32 v[184:185], v[184:185], v[186:187]
v_cvt_pk_bf16_f32 v192, v172, v173
v_cvt_pk_bf16_f32 v193, v176, v177
v_cvt_pk_bf16_f32 v194, v180, v181
v_cvt_pk_bf16_f32 v195, v184, v185
s_nop 0
v_permlane16_swap_b32 v192, v194
s_nop 0
v_permlane16_swap_b32 v193, v195
buffer_store_dwordx4 v[192:195], v4, s[44:47], s66 offen sc1
s_add_u32 s66, s66, 65536
s_waitcnt lgkmcnt(4)
v_pk_fma_f32 v[172:173], v[148:149], v[228:229], v[74:75]
v_pk_fma_f32 v[176:177], v[150:151], v[228:229], v[76:77]
v_pk_fma_f32 v[180:181], v[148:149], v[124:125], v[102:103]
v_pk_fma_f32 v[184:185], v[150:151], v[124:125], v[104:105]
v_pk_mul_f32 v[174:175], v[172:173], v[172:173]
v_pk_mul_f32 v[178:179], v[176:177], v[176:177]
v_pk_mul_f32 v[182:183], v[180:181], v[180:181]
v_pk_mul_f32 v[186:187], v[184:185], v[184:185]
v_pk_fma_f32 v[174:175], v[174:175], v[232:233], v[230:231]
v_pk_fma_f32 v[178:179], v[178:179], v[232:233], v[230:231]
v_pk_fma_f32 v[182:183], v[182:183], v[128:129], v[126:127]
v_pk_fma_f32 v[186:187], v[186:187], v[128:129], v[126:127]
v_pk_mul_f32 v[174:175], v[174:175], v[172:173]
v_pk_mul_f32 v[178:179], v[178:179], v[176:177]
v_pk_mul_f32 v[182:183], v[182:183], v[180:181]
v_pk_mul_f32 v[186:187], v[186:187], v[184:185]
v_exp_f32 v174, v174
v_exp_f32 v175, v175
v_exp_f32 v178, v178
v_exp_f32 v179, v179
v_exp_f32 v182, v182
v_exp_f32 v183, v183
v_exp_f32 v186, v186
v_exp_f32 v187, v187
v_pk_fma_f32 v[174:175], v[174:175], v[234:235], v[234:235]
v_pk_fma_f32 v[178:179], v[178:179], v[234:235], v[234:235]
v_pk_fma_f32 v[182:183], v[182:183], v[130:131], v[130:131]
v_pk_fma_f32 v[186:187], v[186:187], v[130:131], v[130:131]
v_rcp_f32 v174, v174
v_rcp_f32 v175, v175
v_rcp_f32 v178, v178
v_rcp_f32 v179, v179
v_rcp_f32 v182, v182
v_rcp_f32 v183, v183
v_rcp_f32 v186, v186
v_rcp_f32 v187, v187
v_pk_mul_f32 v[172:173], v[172:173], v[174:175]
v_pk_mul_f32 v[176:177], v[176:177], v[178:179]
v_pk_mul_f32 v[180:181], v[180:181], v[182:183]
v_pk_mul_f32 v[184:185], v[184:185], v[186:187]
v_cvt_pk_bf16_f32 v188, v172, v173
v_cvt_pk_bf16_f32 v189, v176, v177
v_cvt_pk_bf16_f32 v190, v180, v181
v_cvt_pk_bf16_f32 v191, v184, v185
s_nop 0
v_permlane16_swap_b32 v188, v190
s_nop 0
v_permlane16_swap_b32 v189, v191
buffer_store_dwordx4 v[188:191], v4, s[44:47], s66 offen sc1
s_add_u32 s66, s66, 65536
s_waitcnt lgkmcnt(3)
v_pk_fma_f32 v[172:173], v[152:153], v[228:229], v[78:79]
v_pk_fma_f32 v[176:177], v[154:155], v[228:229], v[80:81]
v_pk_fma_f32 v[180:181], v[152:153], v[124:125], v[106:107]
v_pk_fma_f32 v[184:185], v[154:155], v[124:125], v[108:109]
v_pk_mul_f32 v[174:175], v[172:173], v[172:173]
v_pk_mul_f32 v[178:179], v[176:177], v[176:177]
v_pk_mul_f32 v[182:183], v[180:181], v[180:181]
v_pk_mul_f32 v[186:187], v[184:185], v[184:185]
v_pk_fma_f32 v[174:175], v[174:175], v[232:233], v[230:231]
v_pk_fma_f32 v[178:179], v[178:179], v[232:233], v[230:231]
v_pk_fma_f32 v[182:183], v[182:183], v[128:129], v[126:127]
v_pk_fma_f32 v[186:187], v[186:187], v[128:129], v[126:127]
v_pk_mul_f32 v[174:175], v[174:175], v[172:173]
v_pk_mul_f32 v[178:179], v[178:179], v[176:177]
v_pk_mul_f32 v[182:183], v[182:183], v[180:181]
v_pk_mul_f32 v[186:187], v[186:187], v[184:185]
v_exp_f32 v174, v174
v_exp_f32 v175, v175
v_exp_f32 v178, v178
v_exp_f32 v179, v179
v_exp_f32 v182, v182
v_exp_f32 v183, v183
v_exp_f32 v186, v186
v_exp_f32 v187, v187
v_pk_fma_f32 v[174:175], v[174:175], v[234:235], v[234:235]
v_pk_fma_f32 v[178:179], v[178:179], v[234:235], v[234:235]
v_pk_fma_f32 v[182:183], v[182:183], v[130:131], v[130:131]
v_pk_fma_f32 v[186:187], v[186:187], v[130:131], v[130:131]
v_rcp_f32 v174, v174
v_rcp_f32 v175, v175
v_rcp_f32 v178, v178
v_rcp_f32 v179, v179
v_rcp_f32 v182, v182
v_rcp_f32 v183, v183
v_rcp_f32 v186, v186
v_rcp_f32 v187, v187
v_pk_mul_f32 v[172:173], v[172:173], v[174:175]
v_pk_mul_f32 v[176:177], v[176:177], v[178:179]
v_pk_mul_f32 v[180:181], v[180:181], v[182:183]
v_pk_mul_f32 v[184:185], v[184:185], v[186:187]
v_cvt_pk_bf16_f32 v192, v172, v173
v_cvt_pk_bf16_f32 v193, v176, v177
v_cvt_pk_bf16_f32 v194, v180, v181
v_cvt_pk_bf16_f32 v195, v184, v185
s_nop 0
v_permlane16_swap_b32 v192, v194
s_nop 0
v_permlane16_swap_b32 v193, v195
buffer_store_dwordx4 v[192:195], v4, s[44:47], s66 offen sc1
s_add_u32 s66, s66, 65536
s_waitcnt lgkmcnt(2)
v_pk_fma_f32 v[172:173], v[156:157], v[228:229], v[82:83]
v_pk_fma_f32 v[176:177], v[158:159], v[228:229], v[84:85]
v_pk_fma_f32 v[180:181], v[156:157], v[124:125], v[110:111]
v_pk_fma_f32 v[184:185], v[158:159], v[124:125], v[112:113]
v_pk_mul_f32 v[174:175], v[172:173], v[172:173]
v_pk_mul_f32 v[178:179], v[176:177], v[176:177]
v_pk_mul_f32 v[182:183], v[180:181], v[180:181]
v_pk_mul_f32 v[186:187], v[184:185], v[184:185]
v_pk_fma_f32 v[174:175], v[174:175], v[232:233], v[230:231]
v_pk_fma_f32 v[178:179], v[178:179], v[232:233], v[230:231]
v_pk_fma_f32 v[182:183], v[182:183], v[128:129], v[126:127]
v_pk_fma_f32 v[186:187], v[186:187], v[128:129], v[126:127]
v_pk_mul_f32 v[174:175], v[174:175], v[172:173]
v_pk_mul_f32 v[178:179], v[178:179], v[176:177]
v_pk_mul_f32 v[182:183], v[182:183], v[180:181]
v_pk_mul_f32 v[186:187], v[186:187], v[184:185]
v_exp_f32 v174, v174
v_exp_f32 v175, v175
v_exp_f32 v178, v178
v_exp_f32 v179, v179
v_exp_f32 v182, v182
v_exp_f32 v183, v183
v_exp_f32 v186, v186
v_exp_f32 v187, v187
v_pk_fma_f32 v[174:175], v[174:175], v[234:235], v[234:235]
v_pk_fma_f32 v[178:179], v[178:179], v[234:235], v[234:235]
v_pk_fma_f32 v[182:183], v[182:183], v[130:131], v[130:131]
v_pk_fma_f32 v[186:187], v[186:187], v[130:131], v[130:131]
v_rcp_f32 v174, v174
v_rcp_f32 v175, v175
v_rcp_f32 v178, v178
v_rcp_f32 v179, v179
v_rcp_f32 v182, v182
v_rcp_f32 v183, v183
v_rcp_f32 v186, v186
v_rcp_f32 v187, v187
v_pk_mul_f32 v[172:173], v[172:173], v[174:175]
v_pk_mul_f32 v[176:177], v[176:177], v[178:179]
v_pk_mul_f32 v[180:181], v[180:181], v[182:183]
v_pk_mul_f32 v[184:185], v[184:185], v[186:187]
v_cvt_pk_bf16_f32 v188, v172, v173
v_cvt_pk_bf16_f32 v189, v176, v177
v_cvt_pk_bf16_f32 v190, v180, v181
v_cvt_pk_bf16_f32 v191, v184, v185
s_nop 0
v_permlane16_swap_b32 v188, v190
s_nop 0
v_permlane16_swap_b32 v189, v191
buffer_store_dwordx4 v[188:191], v4, s[44:47], s66 offen sc1
s_add_u32 s66, s66, 65536
s_waitcnt lgkmcnt(1)
v_pk_fma_f32 v[172:173], v[160:161], v[228:229], v[86:87]
v_pk_fma_f32 v[176:177], v[162:163], v[228:229], v[88:89]
v_pk_fma_f32 v[180:181], v[160:161], v[124:125], v[114:115]
v_pk_fma_f32 v[184:185], v[162:163], v[124:125], v[116:117]
v_pk_mul_f32 v[174:175], v[172:173], v[172:173]
v_pk_mul_f32 v[178:179], v[176:177], v[176:177]
v_pk_mul_f32 v[182:183], v[180:181], v[180:181]
v_pk_mul_f32 v[186:187], v[184:185], v[184:185]
v_pk_fma_f32 v[174:175], v[174:175], v[232:233], v[230:231]
v_pk_fma_f32 v[178:179], v[178:179], v[232:233], v[230:231]
v_pk_fma_f32 v[182:183], v[182:183], v[128:129], v[126:127]
v_pk_fma_f32 v[186:187], v[186:187], v[128:129], v[126:127]
v_pk_mul_f32 v[174:175], v[174:175], v[172:173]
v_pk_mul_f32 v[178:179], v[178:179], v[176:177]
v_pk_mul_f32 v[182:183], v[182:183], v[180:181]
v_pk_mul_f32 v[186:187], v[186:187], v[184:185]
v_exp_f32 v174, v174
v_exp_f32 v175, v175
v_exp_f32 v178, v178
v_exp_f32 v179, v179
v_exp_f32 v182, v182
v_exp_f32 v183, v183
v_exp_f32 v186, v186
v_exp_f32 v187, v187
v_pk_fma_f32 v[174:175], v[174:175], v[234:235], v[234:235]
v_pk_fma_f32 v[178:179], v[178:179], v[234:235], v[234:235]
v_pk_fma_f32 v[182:183], v[182:183], v[130:131], v[130:131]
v_pk_fma_f32 v[186:187], v[186:187], v[130:131], v[130:131]
v_rcp_f32 v174, v174
v_rcp_f32 v175, v175
v_rcp_f32 v178, v178
v_rcp_f32 v179, v179
v_rcp_f32 v182, v182
v_rcp_f32 v183, v183
v_rcp_f32 v186, v186
v_rcp_f32 v187, v187
v_pk_mul_f32 v[172:173], v[172:173], v[174:175]
v_pk_mul_f32 v[176:177], v[176:177], v[178:179]
v_pk_mul_f32 v[180:181], v[180:181], v[182:183]
v_pk_mul_f32 v[184:185], v[184:185], v[186:187]
v_cvt_pk_bf16_f32 v192, v172, v173
v_cvt_pk_bf16_f32 v193, v176, v177
v_cvt_pk_bf16_f32 v194, v180, v181
v_cvt_pk_bf16_f32 v195, v184, v185
s_nop 0
v_permlane16_swap_b32 v192, v194
s_nop 0
v_permlane16_swap_b32 v193, v195
buffer_store_dwordx4 v[192:195], v4, s[44:47], s66 offen sc1
s_add_u32 s66, s66, 65536
s_waitcnt lgkmcnt(0)
v_pk_fma_f32 v[172:173], v[164:165], v[228:229], v[90:91]
v_pk_fma_f32 v[176:177], v[166:167], v[228:229], v[92:93]
v_pk_fma_f32 v[180:181], v[164:165], v[124:125], v[118:119]
v_pk_fma_f32 v[184:185], v[166:167], v[124:125], v[120:121]
v_pk_mul_f32 v[174:175], v[172:173], v[172:173]
v_pk_mul_f32 v[178:179], v[176:177], v[176:177]
v_pk_mul_f32 v[182:183], v[180:181], v[180:181]
v_pk_mul_f32 v[186:187], v[184:185], v[184:185]
v_pk_fma_f32 v[174:175], v[174:175], v[232:233], v[230:231]
v_pk_fma_f32 v[178:179], v[178:179], v[232:233], v[230:231]
v_pk_fma_f32 v[182:183], v[182:183], v[128:129], v[126:127]
v_pk_fma_f32 v[186:187], v[186:187], v[128:129], v[126:127]
v_pk_mul_f32 v[174:175], v[174:175], v[172:173]
v_pk_mul_f32 v[178:179], v[178:179], v[176:177]
v_pk_mul_f32 v[182:183], v[182:183], v[180:181]
v_pk_mul_f32 v[186:187], v[186:187], v[184:185]
v_exp_f32 v174, v174
v_exp_f32 v175, v175
v_exp_f32 v178, v178
v_exp_f32 v179, v179
v_exp_f32 v182, v182
v_exp_f32 v183, v183
v_exp_f32 v186, v186
v_exp_f32 v187, v187
v_pk_fma_f32 v[174:175], v[174:175], v[234:235], v[234:235]
v_pk_fma_f32 v[178:179], v[178:179], v[234:235], v[234:235]
v_pk_fma_f32 v[182:183], v[182:183], v[130:131], v[130:131]
v_pk_fma_f32 v[186:187], v[186:187], v[130:131], v[130:131]
v_rcp_f32 v174, v174
v_rcp_f32 v175, v175
v_rcp_f32 v178, v178
v_rcp_f32 v179, v179
v_rcp_f32 v182, v182
v_rcp_f32 v183, v183
v_rcp_f32 v186, v186
v_rcp_f32 v187, v187
v_pk_mul_f32 v[172:173], v[172:173], v[174:175]
v_pk_mul_f32 v[176:177], v[176:177], v[178:179]
v_pk_mul_f32 v[180:181], v[180:181], v[182:183]
v_pk_mul_f32 v[184:185], v[184:185], v[186:187]
v_cvt_pk_bf16_f32 v188, v172, v173
v_cvt_pk_bf16_f32 v189, v176, v177
v_cvt_pk_bf16_f32 v190, v180, v181
v_cvt_pk_bf16_f32 v191, v184, v185
s_nop 0
v_permlane16_swap_b32 v188, v190
s_nop 0
v_permlane16_swap_b32 v189, v191
buffer_store_dwordx4 v[188:191], v4, s[44:47], s66 offen sc1
s_add_u32 s66, s66, 65536
v_lshl_add_u32 v1, v57, 3, v59
v_add_u32 v1, v1, v60
v_lshlrev_b32 v1, 3, v1
s_mul_i32 s65, s78, 4128
s_add_u32 s3, s65, 149512
v_add_u32 v68, s3, v1
v_lshlrev_b32 v1, 5, v60
v_lshlrev_b32 v2, 6, v57
v_sub_u32 v1, v1, v2
v_lshlrev_b32 v2, 3, v59
v_sub_u32 v1, v1, v2
s_mul_i32 s64, s78, 4352
s_lshl_b32 s63, s79, 7
s_add_u32 s3, s64, s63
s_add_u32 s3, s3, 131320
v_add_u32 v69, s3, v1
ds_read_b64_tr_b16 a[192:193], v68 offset:0
ds_read_b64_tr_b16 a[194:195], v68 offset:32
ds_read_b64_tr_b16 v[136:137], v69 offset:32
ds_read_b64_tr_b16 v[138:139], v69 offset:0
ds_read_b64_tr_b16 a[196:197], v68 offset:256
ds_read_b64_tr_b16 a[198:199], v68 offset:288
ds_read_b64_tr_b16 v[140:141], v69 offset:288
ds_read_b64_tr_b16 v[142:143], v69 offset:256
ds_read_b64_tr_b16 a[200:201], v68 offset:512
ds_read_b64_tr_b16 a[202:203], v68 offset:544
ds_read_b64_tr_b16 v[144:145], v69 offset:544
ds_read_b64_tr_b16 v[146:147], v69 offset:512
ds_read_b64_tr_b16 a[204:205], v68 offset:768
ds_read_b64_tr_b16 a[206:207], v68 offset:800
ds_read_b64_tr_b16 v[148:149], v69 offset:800
ds_read_b64_tr_b16 v[150:151], v69 offset:768
s_lshl_b32 s3, s79, 12
v_add_u32 v64, s3, v15
v_xor_b32 v65, 32, v64
v_xor_b32 v66, 64, v64
v_xor_b32 v67, 96, v64
v_lshlrev_b32 v13, 2, v58
s_mul_i32 s67, s78, -9728
s_add_u32 s67, s67, 149504
s_lshl_b32 s63, s79, 8
s_add_u32 s3, s67, s63
v_add_u32 v13, s3, v13
s_mul_i32 s66, s78, 528
s_add_u32 s66, s66, 157760
s_lshl_b32 s63, s79, 4
s_add_u32 s3, s66, s63
v_mov_b32 v14, s3
s_lshl_b32 s73, s60, 7
s_add_u32 s73, s73, 8192
s_waitcnt vmcnt(8)
s_barrier
s_waitcnt lgkmcnt(12)
v_mfma_f32_16x16x32_bf16 v[72:75], v[136:139], a[192:195], 0
ds_read_b64_tr_b16 a[208:209], v68 offset:1024
ds_read_b64_tr_b16 a[210:211], v68 offset:1056
s_waitcnt lgkmcnt(10)
v_mfma_f32_16x16x32_bf16 v[76:79], v[140:143], a[192:195], 0
s_add_u32 s72, s70, 262144
s_add_u32 m0, s71, 65536
v_mfma_f32_16x16x32_bf16 v[76:79], v[136:139], a[196:199], v[76:79]
ds_read_b64_tr_b16 v[152:153], v69 offset:1056
ds_read_b64_tr_b16 v[154:155], v69 offset:1024
s_waitcnt lgkmcnt(8)
v_mfma_f32_16x16x32_bf16 v[80:83], v[144:147], a[192:195], 0
ds_read_b64_tr_b16 a[212:213], v68 offset:1280
ds_read_b64_tr_b16 a[214:215], v68 offset:1312
v_mfma_f32_16x16x32_bf16 v[80:83], v[140:143], a[196:199], v[80:83]
buffer_load_dwordx4 v8, s[32:35], s72 offen offset:0 lds
v_mfma_f32_16x16x32_bf16 v[80:83], v[136:139], a[200:203], v[80:83]
ds_read_b64_tr_b16 v[156:157], v69 offset:1312
ds_read_b64_tr_b16 v[158:159], v69 offset:1280
s_waitcnt lgkmcnt(8)
v_mfma_f32_16x16x32_bf16 v[84:87], v[148:151], a[192:195], 0
ds_read_b64_tr_b16 a[216:217], v68 offset:1536
ds_read_b64_tr_b16 a[218:219], v68 offset:1568
v_mfma_f32_16x16x32_bf16 v[84:87], v[144:147], a[196:199], v[84:87]
buffer_load_dwordx4 v9, s[32:35], s72 offen offset:1024 lds
v_mfma_f32_16x16x32_bf16 v[84:87], v[140:143], a[200:203], v[84:87]
ds_read_b64_tr_b16 v[160:161], v69 offset:1568
ds_read_b64_tr_b16 v[162:163], v69 offset:1536
v_mfma_f32_16x16x32_bf16 v[84:87], v[136:139], a[204:207], v[84:87]
ds_read_b64_tr_b16 a[220:221], v68 offset:1792
ds_read_b64_tr_b16 a[222:223], v68 offset:1824
s_waitcnt lgkmcnt(10)
v_mfma_f32_16x16x32_bf16 v[88:91], v[152:155], a[192:195], 0
buffer_load_dwordx4 v10, s[32:35], s72 offen offset:2048 lds
v_mfma_f32_16x16x32_bf16 v[88:91], v[148:151], a[196:199], v[88:91]
ds_read_b64_tr_b16 v[164:165], v69 offset:1824
ds_read_b64_tr_b16 v[166:167], v69 offset:1792
v_mfma_f32_16x16x32_bf16 v[88:91], v[144:147], a[200:203], v[88:91]
ds_read_b64_tr_b16 a[224:225], v68 offset:2048
ds_read_b64_tr_b16 a[226:227], v68 offset:2080
v_mfma_f32_16x16x32_bf16 v[88:91], v[140:143], a[204:207], v[88:91]
buffer_load_dwordx4 v11, s[32:35], s72 offen offset:3072 lds
v_mfma_f32_16x16x32_bf16 v[88:91], v[136:139], a[208:211], v[88:91]
ds_read_b64_tr_b16 v[168:169], v69 offset:2080
ds_read_b64_tr_b16 v[170:171], v69 offset:2048
s_waitcnt lgkmcnt(12)
v_mfma_f32_16x16x32_bf16 v[92:95], v[156:159], a[192:195], 0
ds_read_b64_tr_b16 a[228:229], v68 offset:2304
ds_read_b64_tr_b16 a[230:231], v68 offset:2336
v_mfma_f32_16x16x32_bf16 v[92:95], v[152:155], a[196:199], v[92:95]
s_add_u32 s72, s70, 327680
s_add_u32 m0, s71, 81920
v_mfma_f32_16x16x32_bf16 v[92:95], v[148:151], a[200:203], v[92:95]
ds_read_b64_tr_b16 v[172:173], v69 offset:2336
ds_read_b64_tr_b16 v[174:175], v69 offset:2304
v_mfma_f32_16x16x32_bf16 v[92:95], v[144:147], a[204:207], v[92:95]
ds_read_b64_tr_b16 a[232:233], v68 offset:2560
ds_read_b64_tr_b16 a[234:235], v68 offset:2592
v_mfma_f32_16x16x32_bf16 v[92:95], v[140:143], a[208:211], v[92:95]
buffer_load_dwordx4 v8, s[32:35], s72 offen offset:0 lds
v_mfma_f32_16x16x32_bf16 v[92:95], v[136:139], a[212:215], v[92:95]
ds_read_b64_tr_b16 v[176:177], v69 offset:2592
ds_read_b64_tr_b16 v[178:179], v69 offset:2560
s_waitcnt lgkmcnt(15)
v_mfma_f32_16x16x32_bf16 v[96:99], v[160:163], a[192:195], 0
ds_read_b64_tr_b16 a[236:237], v68 offset:2816
ds_read_b64_tr_b16 a[238:239], v68 offset:2848
v_mfma_f32_16x16x32_bf16 v[96:99], v[156:159], a[196:199], v[96:99]
buffer_load_dwordx4 v9, s[32:35], s72 offen offset:1024 lds
v_mfma_f32_16x16x32_bf16 v[96:99], v[152:155], a[200:203], v[96:99]
ds_read_b64_tr_b16 v[180:181], v69 offset:2848
ds_read_b64_tr_b16 v[182:183], v69 offset:2816
v_mfma_f32_16x16x32_bf16 v[96:99], v[148:151], a[204:207], v[96:99]
ds_read_b64_tr_b16 a[240:241], v68 offset:3072
ds_read_b64_tr_b16 a[242:243], v68 offset:3104
v_mfma_f32_16x16x32_bf16 v[96:99], v[144:147], a[208:211], v[96:99]
buffer_load_dwordx4 v10, s[32:35], s72 offen offset:2048 lds
v_mfma_f32_16x16x32_bf16 v[96:99], v[140:143], a[212:215], v[96:99]
ds_read_b64_tr_b16 v[184:185], v69 offset:3104
ds_read_b64_tr_b16 v[186:187], v69 offset:3072
v_mfma_f32_16x16x32_bf16 v[96:99], v[136:139], a[216:219], v[96:99]
ds_read_b64_tr_b16 a[244:245], v68 offset:3328
ds_read_b64_tr_b16 a[246:247], v68 offset:3360
s_waitcnt lgkmcnt(15)
v_mfma_f32_16x16x32_bf16 v[100:103], v[164:167], a[192:195], 0
buffer_load_dwordx4 v11, s[32:35], s72 offen offset:3072 lds
v_mfma_f32_16x16x32_bf16 v[100:103], v[160:163], a[196:199], v[100:103]
ds_read_b64_tr_b16 v[188:189], v69 offset:3360
ds_read_b64_tr_b16 v[190:191], v69 offset:3328
v_mfma_f32_16x16x32_bf16 v[100:103], v[156:159], a[200:203], v[100:103]
ds_read_b64_tr_b16 a[248:249], v68 offset:3584
ds_read_b64_tr_b16 a[250:251], v68 offset:3616
v_mfma_f32_16x16x32_bf16 v[100:103], v[152:155], a[204:207], v[100:103]
s_add_u32 s72, s70, 393216
s_add_u32 m0, s71, 98304
v_mfma_f32_16x16x32_bf16 v[100:103], v[148:151], a[208:211], v[100:103]
ds_read_b64_tr_b16 v[192:193], v69 offset:3616
ds_read_b64_tr_b16 v[194:195], v69 offset:3584
v_mfma_f32_16x16x32_bf16 v[100:103], v[144:147], a[212:215], v[100:103]
ds_read_b64_tr_b16 a[252:253], v68 offset:3840
ds_read_b64_tr_b16 a[254:255], v68 offset:3872
v_mfma_f32_16x16x32_bf16 v[100:103], v[140:143], a[216:219], v[100:103]
buffer_load_dwordx4 v8, s[32:35], s72 offen offset:0 lds
v_mfma_f32_16x16x32_bf16 v[100:103], v[136:139], a[220:223], v[100:103]
ds_read_b64_tr_b16 v[196:197], v69 offset:3872
ds_read_b64_tr_b16 v[198:199], v69 offset:3840
v_mfma_f32_16x16x32_bf16 v[104:107], v[168:171], a[192:195], 0
v_add_f32_dpp v74, v75, v74 wave_shr:1 row_mask:0xf bank_mask:0xf bound_ctrl:0
ds_read_b64_tr_b16 a[0:1], v64 offset:0
v_mfma_f32_16x16x32_bf16 v[104:107], v[164:167], a[196:199], v[104:107]
buffer_load_dwordx4 v9, s[32:35], s72 offen offset:1024 lds
v_mfma_f32_16x16x32_bf16 v[104:107], v[160:163], a[200:203], v[104:107]
v_add_f32_dpp v73, v74, v73 wave_shr:1 row_mask:0xf bank_mask:0xf bound_ctrl:0
ds_read_b64_tr_b16 a[2:3], v64 offset:512
v_mfma_f32_16x16x32_bf16 v[104:107], v[156:159], a[204:207], v[104:107]
v_add_f32_dpp v72, v73, v72 wave_shr:1 row_mask:0xf bank_mask:0xf bound_ctrl:0
ds_read_b64_tr_b16 a[4:5], v65 offset:0
v_mfma_f32_16x16x32_bf16 v[104:107], v[152:155], a[208:211], v[104:107]
buffer_load_dwordx4 v10, s[32:35], s72 offen offset:2048 lds
v_mfma_f32_16x16x32_bf16 v[104:107], v[148:151], a[212:215], v[104:107]
v_add_f32_dpp v78, v79, v78 wave_shr:1 row_mask:0xf bank_mask:0xf bound_ctrl:0
ds_read_b64_tr_b16 a[6:7], v65 offset:512
v_mfma_f32_16x16x32_bf16 v[104:107], v[144:147], a[216:219], v[104:107]
v_add_f32_dpp v77, v78, v77 wave_shr:1 row_mask:0xf bank_mask:0xf bound_ctrl:0
ds_read_b64_tr_b16 a[8:9], v66 offset:0
v_mfma_f32_16x16x32_bf16 v[104:107], v[140:143], a[220:223], v[104:107]
buffer_load_dwordx4 v11, s[32:35], s72 offen offset:3072 lds
v_mfma_f32_16x16x32_bf16 v[104:107], v[136:139], a[224:227], v[104:107]
v_add_f32_dpp v76, v77, v76 wave_shr:1 row_mask:0xf bank_mask:0xf bound_ctrl:0
ds_read_b64_tr_b16 a[10:11], v66 offset:512
s_waitcnt lgkmcnt(15)
v_mfma_f32_16x16x32_bf16 v[108:111], v[172:175], a[192:195], 0
v_add_f32_dpp v82, v83, v82 wave_shr:1 row_mask:0xf bank_mask:0xf bound_ctrl:0
ds_read_b64_tr_b16 a[12:13], v67 offset:0
v_mfma_f32_16x16x32_bf16 v[108:111], v[168:171], a[196:199], v[108:111]
s_add_u32 s72, s70, 458752
s_add_u32 m0, s71, 114688
v_mfma_f32_16x16x32_bf16 v[108:111], v[164:167], a[200:203], v[108:111]
v_add_f32_dpp v81, v82, v81 wave_shr:1 row_mask:0xf bank_mask:0xf bound_ctrl:0
ds_read_b64_tr_b16 a[14:15], v67 offset:512
v_mfma_f32_16x16x32_bf16 v[108:111], v[160:163], a[204:207], v[108:111]
v_add_f32_dpp v80, v81, v80 wave_shr:1 row_mask:0xf bank_mask:0xf bound_ctrl:0
ds_read_b64_tr_b16 a[16:17], v64 offset:8192
v_mfma_f32_16x16x32_bf16 v[108:111], v[156:159], a[208:211], v[108:111]
buffer_load_dwordx4 v8, s[32:35], s72 offen offset:0 lds
v_mfma_f32_16x16x32_bf16 v[108:111], v[152:155], a[212:215], v[108:111]
v_add_f32_dpp v86, v87, v86 wave_shr:1 row_mask:0xf bank_mask:0xf bound_ctrl:0
ds_read_b64_tr_b16 a[18:19], v64 offset:8704
v_mfma_f32_16x16x32_bf16 v[108:111], v[148:151], a[216:219], v[108:111]
v_add_f32_dpp v85, v86, v85 wave_shr:1 row_mask:0xf bank_mask:0xf bound_ctrl:0
ds_read_b64_tr_b16 a[20:21], v65 offset:8192
v_mfma_f32_16x16x32_bf16 v[108:111], v[144:147], a[220:223], v[108:111]
buffer_load_dwordx4 v9, s[32:35], s72 offen offset:1024 lds
v_mfma_f32_16x16x32_bf16 v[108:111], v[140:143], a[224:227], v[108:111]
v_add_f32_dpp v84, v85, v84 wave_shr:1 row_mask:0xf bank_mask:0xf bound_ctrl:0
ds_read_b64_tr_b16 a[22:23], v65 offset:8704
v_mfma_f32_16x16x32_bf16 v[108:111], v[136:139], a[228:231], v[108:111]
v_add_f32_dpp v90, v91, v90 wave_shr:1 row_mask:0xf bank_mask:0xf bound_ctrl:0
ds_read_b64_tr_b16 a[24:25], v66 offset:8192
v_mfma_f32_16x16x32_bf16 v[112:115], v[176:179], a[192:195], 0
buffer_load_dwordx4 v10, s[32:35], s72 offen offset:2048 lds
v_mfma_f32_16x16x32_bf16 v[112:115], v[172:175], a[196:199], v[112:115]
v_add_f32_dpp v89, v90, v89 wave_shr:1 row_mask:0xf bank_mask:0xf bound_ctrl:0
ds_read_b64_tr_b16 a[26:27], v66 offset:8704
v_mfma_f32_16x16x32_bf16 v[112:115], v[168:171], a[200:203], v[112:115]
v_add_f32_dpp v88, v89, v88 wave_shr:1 row_mask:0xf bank_mask:0xf bound_ctrl:0
ds_read_b64_tr_b16 a[28:29], v67 offset:8192
v_mfma_f32_16x16x32_bf16 v[112:115], v[164:167], a[204:207], v[112:115]
buffer_load_dwordx4 v11, s[32:35], s72 offen offset:3072 lds
v_mfma_f32_16x16x32_bf16 v[112:115], v[160:163], a[208:211], v[112:115]
v_add_f32_dpp v94, v95, v94 wave_shr:1 row_mask:0xf bank_mask:0xf bound_ctrl:0
ds_read_b64_tr_b16 a[30:31], v67 offset:8704
v_mfma_f32_16x16x32_bf16 v[112:115], v[156:159], a[212:215], v[112:115]
v_add_f32_dpp v93, v94, v93 wave_shr:1 row_mask:0xf bank_mask:0xf bound_ctrl:0
ds_read_b64_tr_b16 a[32:33], v64 offset:16384
v_mfma_f32_16x16x32_bf16 v[112:115], v[152:155], a[216:219], v[112:115]
v_add_f32_dpp v92, v93, v92 wave_shr:1 row_mask:0xf bank_mask:0xf bound_ctrl:0
ds_read_b64_tr_b16 a[34:35], v64 offset:16896
ds_read_b64_tr_b16 a[36:37], v65 offset:16384
ds_read_b64_tr_b16 a[38:39], v65 offset:16896
ds_read_b64_tr_b16 a[40:41], v66 offset:16384
ds_read_b64_tr_b16 a[42:43], v66 offset:16896
ds_read_b64_tr_b16 a[44:45], v67 offset:16384
ds_read_b64_tr_b16 a[46:47], v67 offset:16896
ds_read_b64_tr_b16 a[48:49], v64 offset:24576
ds_read_b64_tr_b16 a[50:51], v64 offset:25088
ds_read_b64_tr_b16 a[52:53], v65 offset:24576
ds_read_b64_tr_b16 a[54:55], v65 offset:25088
ds_read_b64_tr_b16 a[56:57], v66 offset:24576
ds_read_b64_tr_b16 a[58:59], v66 offset:25088
ds_read_b64_tr_b16 a[60:61], v67 offset:24576
ds_read_b64_tr_b16 a[62:63], v67 offset:25088
ds_read_b64_tr_b16 a[64:65], v64 offset:32768
ds_read_b64_tr_b16 a[66:67], v64 offset:33280
ds_read_b64_tr_b16 a[68:69], v65 offset:32768
ds_read_b64_tr_b16 a[70:71], v65 offset:33280
ds_read_b64_tr_b16 a[72:73], v66 offset:32768
ds_read_b64_tr_b16 a[74:75], v66 offset:33280
ds_read_b64_tr_b16 a[76:77], v67 offset:32768
ds_read_b64_tr_b16 a[78:79], v67 offset:33280
ds_read_b64_tr_b16 a[80:81], v64 offset:40960
ds_read_b64_tr_b16 a[82:83], v64 offset:41472
ds_read_b64_tr_b16 a[84:85], v65 offset:40960
ds_read_b64_tr_b16 a[86:87], v65 offset:41472
ds_read_b64_tr_b16 a[88:89], v66 offset:40960
ds_read_b64_tr_b16 a[90:91], v66 offset:41472
ds_read_b64_tr_b16 a[92:93], v67 offset:40960
ds_read_b64_tr_b16 a[94:95], v67 offset:41472
ds_read_b64_tr_b16 a[96:97], v64 offset:49152
ds_read_b64_tr_b16 a[98:99], v64 offset:49664
ds_read_b64_tr_b16 a[100:101], v65 offset:49152
ds_read_b64_tr_b16 a[102:103], v65 offset:49664
ds_read_b64_tr_b16 a[104:105], v66 offset:49152
ds_read_b64_tr_b16 a[106:107], v66 offset:49664
ds_read_b64_tr_b16 a[108:109], v67 offset:49152
ds_read_b64_tr_b16 a[110:111], v67 offset:49664
ds_read_b64_tr_b16 a[112:113], v64 offset:57344
ds_read_b64_tr_b16 a[114:115], v64 offset:57856
ds_read_b64_tr_b16 a[116:117], v65 offset:57344
ds_read_b64_tr_b16 a[118:119], v65 offset:57856
ds_read_b64_tr_b16 a[120:121], v66 offset:57344
ds_read_b64_tr_b16 a[122:123], v66 offset:57856
ds_read_b64_tr_b16 a[124:125], v67 offset:57344
ds_read_b64_tr_b16 a[126:127], v67 offset:57856
s_waitcnt lgkmcnt(0)
s_waitcnt vmcnt(16)
s_barrier
s_cmp_lg_u32 s4, 0
s_cbranch_scc1 L_sig_17
s_mov_b64 exec, 1
v_mov_b32 v255, 1
buffer_atomic_add v255, v62, s[44:47], s73 offen sc1
s_mov_b64 exec, -1
L_sig_17:
v_mfma_f32_16x16x32_bf16 v[112:115], v[148:151], a[220:223], v[112:115]
v_add_u32 v64, 65536, v64
v_mfma_f32_16x16x32_bf16 v[112:115], v[144:147], a[224:227], v[112:115]
v_add_u32 v65, 65536, v65
ds_write_b32 v13, v72 offset:0
v_mfma_f32_16x16x32_bf16 v[112:115], v[140:143], a[228:231], v[112:115]
s_add_u32 s72, s70, 524288
s_add_u32 m0, s71, 0
v_mfma_f32_16x16x32_bf16 v[112:115], v[136:139], a[232:235], v[112:115]
v_add_u32 v66, 65536, v66
ds_write_b32 v13, v76 offset:512
v_mfma_f32_16x16x32_bf16 v[116:119], v[180:183], a[192:195], 0
v_add_u32 v67, 65536, v67
ds_write_b32 v13, v80 offset:1024
v_mfma_f32_16x16x32_bf16 v[116:119], v[176:179], a[196:199], v[116:119]
buffer_load_dwordx4 v8, s[32:35], s72 offen offset:0 lds
v_mfma_f32_16x16x32_bf16 v[116:119], v[172:175], a[200:203], v[116:119]
v_add_f32_dpp v98, v99, v98 wave_shr:1 row_mask:0xf bank_mask:0xf bound_ctrl:0
ds_write_b32 v13, v84 offset:1536
v_mfma_f32_16x16x32_bf16 v[116:119], v[168:171], a[204:207], v[116:119]
v_add_f32_dpp v97, v98, v97 wave_shr:1 row_mask:0xf bank_mask:0xf bound_ctrl:0
ds_write_b32 v13, v88 offset:2048
v_mfma_f32_16x16x32_bf16 v[116:119], v[164:167], a[208:211], v[116:119]
buffer_load_dwordx4 v9, s[32:35], s72 offen offset:1024 lds
v_mfma_f32_16x16x32_bf16 v[116:119], v[160:163], a[212:215], v[116:119]
v_add_f32_dpp v96, v97, v96 wave_shr:1 row_mask:0xf bank_mask:0xf bound_ctrl:0
ds_write_b32 v13, v92 offset:2560
v_mfma_f32_16x16x32_bf16 v[116:119], v[156:159], a[216:219], v[116:119]
v_add_f32_dpp v102, v103, v102 wave_shr:1 row_mask:0xf bank_mask:0xf bound_ctrl:0
ds_write_b32 v13, v96 offset:3072
v_mfma_f32_16x16x32_bf16 v[116:119], v[152:155], a[220:223], v[116:119]
buffer_load_dwordx4 v10, s[32:35], s72 offen offset:2048 lds
v_mfma_f32_16x16x32_bf16 v[116:119], v[148:151], a[224:227], v[116:119]
v_add_f32_dpp v101, v102, v101 wave_shr:1 row_mask:0xf bank_mask:0xf bound_ctrl:0
v_mfma_f32_16x16x32_bf16 v[116:119], v[144:147], a[228:231], v[116:119]
s_nop 0
v_add_f32_dpp v100, v101, v100 wave_shr:1 row_mask:0xf bank_mask:0xf bound_ctrl:0
ds_write_b32 v13, v100 offset:3584
v_mfma_f32_16x16x32_bf16 v[116:119], v[140:143], a[232:235], v[116:119]
buffer_load_dwordx4 v11, s[32:35], s72 offen offset:3072 lds
v_mfma_f32_16x16x32_bf16 v[116:119], v[136:139], a[236:239], v[116:119]
v_add_f32_dpp v106, v107, v106 wave_shr:1 row_mask:0xf bank_mask:0xf bound_ctrl:0
v_mfma_f32_16x16x32_bf16 v[120:123], v[184:187], a[192:195], 0
s_nop 0
v_add_f32_dpp v105, v106, v105 wave_shr:1 row_mask:0xf bank_mask:0xf bound_ctrl:0
v_mfma_f32_16x16x32_bf16 v[120:123], v[180:183], a[196:199], v[120:123]
s_add_u32 s72, s70, 589824
s_add_u32 m0, s71, 16384
v_mfma_f32_16x16x32_bf16 v[120:123], v[176:179], a[200:203], v[120:123]
v_add_f32_dpp v104, v105, v104 wave_shr:1 row_mask:0xf bank_mask:0xf bound_ctrl:0
ds_write_b32 v13, v104 offset:4096
v_mfma_f32_16x16x32_bf16 v[120:123], v[172:175], a[204:207], v[120:123]
v_add_f32_dpp v110, v111, v110 wave_shr:1 row_mask:0xf bank_mask:0xf bound_ctrl:0
v_mfma_f32_16x16x32_bf16 v[120:123], v[168:171], a[208:211], v[120:123]
buffer_load_dwordx4 v8, s[32:35], s72 offen offset:0 lds
v_mfma_f32_16x16x32_bf16 v[120:123], v[164:167], a[212:215], v[120:123]
v_add_f32_dpp v109, v110, v109 wave_shr:1 row_mask:0xf bank_mask:0xf bound_ctrl:0
v_mfma_f32_16x16x32_bf16 v[120:123], v[160:163], a[216:219], v[120:123]
s_nop 0
v_add_f32_dpp v108, v109, v108 wave_shr:1 row_mask:0xf bank_mask:0xf bound_ctrl:0
ds_write_b32 v13, v108 offset:4608
v_mfma_f32_16x16x32_bf16 v[120:123], v[156:159], a[220:223], v[120:123]
buffer_load_dwordx4 v9, s[32:35], s72 offen offset:1024 lds
v_mfma_f32_16x16x32_bf16 v[120:123], v[152:155], a[224:227], v[120:123]
v_add_f32_dpp v114, v115, v114 wave_shr:1 row_mask:0xf bank_mask:0xf bound_ctrl:0
v_mfma_f32_16x16x32_bf16 v[120:123], v[148:151], a[228:231], v[120:123]
s_nop 0
v_add_f32_dpp v113, v114, v113 wave_shr:1 row_mask:0xf bank_mask:0xf bound_ctrl:0
s_waitcnt vmcnt(6)
s_barrier
v_mfma_f32_16x16x32_bf16 v[120:123], v[144:147], a[232:235], v[120:123]
buffer_load_dwordx4 v10, s[32:35], s72 offen offset:2048 lds
v_mfma_f32_16x16x32_bf16 v[120:123], v[140:143], a[236:239], v[120:123]
v_add_f32_dpp v112, v113, v112 wave_shr:1 row_mask:0xf bank_mask:0xf bound_ctrl:0
ds_read_b64_tr_b16 a[128:129], v64 offset:0
v_mfma_f32_16x16x32_bf16 v[120:123], v[136:139], a[240:243], v[120:123]
ds_read_b64_tr_b16 a[130:131], v64 offset:512
ds_read_b64_tr_b16 a[132:133], v65 offset:0
v_mfma_f32_16x16x32_bf16 v[124:127], v[188:191], a[192:195], 0
buffer_load_dwordx4 v11, s[32:35], s72 offen offset:3072 lds
v_mfma_f32_16x16x32_bf16 v[124:127], v[184:187], a[196:199], v[124:127]
v_add_f32_dpp v118, v119, v118 wave_shr:1 row_mask:0xf bank_mask:0xf bound_ctrl:0
ds_read_b64_tr_b16 a[134:135], v65 offset:512
v_mfma_f32_16x16x32_bf16 v[124:127], v[180:183], a[200:203], v[124:127]
v_add_f32_dpp v117, v118, v117 wave_shr:1 row_mask:0xf bank_mask:0xf bound_ctrl:0
ds_read_b64_tr_b16 a[136:137], v66 offset:0
v_mfma_f32_16x16x32_bf16 v[124:127], v[176:179], a[204:207], v[124:127]
s_add_u32 s72, s70, 655360
s_add_u32 m0, s71, 32768
v_mfma_f32_16x16x32_bf16 v[124:127], v[172:175], a[208:211], v[124:127]
v_add_f32_dpp v116, v117, v116 wave_shr:1 row_mask:0xf bank_mask:0xf bound_ctrl:0
ds_read_b64_tr_b16 a[138:139], v66 offset:512
v_mfma_f32_16x16x32_bf16 v[124:127], v[168:171], a[212:215], v[124:127]
ds_read_b64_tr_b16 a[140:141], v67 offset:0
ds_read_b64_tr_b16 a[142:143], v67 offset:512
v_mfma_f32_16x16x32_bf16 v[124:127], v[164:167], a[216:219], v[124:127]
buffer_load_dwordx4 v8, s[32:35], s72 offen offset:0 lds
v_mfma_f32_16x16x32_bf16 v[124:127], v[160:163], a[220:223], v[124:127]
ds_read_b64_tr_b16 a[144:145], v64 offset:8192
ds_read_b64_tr_b16 a[146:147], v64 offset:8704
v_mfma_f32_16x16x32_bf16 v[124:127], v[156:159], a[224:227], v[124:127]
ds_read_b64_tr_b16 a[148:149], v65 offset:8192
ds_read_b64_tr_b16 a[150:151], v65 offset:8704
v_mfma_f32_16x16x32_bf16 v[124:127], v[152:155], a[228:231], v[124:127]
buffer_load_dwordx4 v9, s[32:35], s72 offen offset:1024 lds
v_mfma_f32_16x16x32_bf16 v[124:127], v[148:151], a[232:235], v[124:127]
ds_read_b64_tr_b16 a[152:153], v66 offset:8192
ds_read_b64_tr_b16 a[154:155], v66 offset:8704
v_mfma_f32_16x16x32_bf16 v[124:127], v[144:147], a[236:239], v[124:127]
ds_read_b64_tr_b16 a[156:157], v67 offset:8192
ds_read_b64_tr_b16 a[158:159], v67 offset:8704
v_mfma_f32_16x16x32_bf16 v[124:127], v[140:143], a[240:243], v[124:127]
buffer_load_dwordx4 v10, s[32:35], s72 offen offset:2048 lds
v_mfma_f32_16x16x32_bf16 v[124:127], v[136:139], a[244:247], v[124:127]
ds_read_b64_tr_b16 a[160:161], v64 offset:16384
ds_read_b64_tr_b16 a[162:163], v64 offset:16896
v_mfma_f32_16x16x32_bf16 v[128:131], v[192:195], a[192:195], 0
v_add_f32_dpp v122, v123, v122 wave_shr:1 row_mask:0xf bank_mask:0xf bound_ctrl:0
ds_read_b64_tr_b16 a[164:165], v65 offset:16384
v_mfma_f32_16x16x32_bf16 v[128:131], v[188:191], a[196:199], v[128:131]
buffer_load_dwordx4 v11, s[32:35], s72 offen offset:3072 lds
v_mfma_f32_16x16x32_bf16 v[128:131], v[184:187], a[200:203], v[128:131]
v_add_f32_dpp v121, v122, v121 wave_shr:1 row_mask:0xf bank_mask:0xf bound_ctrl:0
ds_read_b64_tr_b16 a[166:167], v65 offset:16896
ds_read_b64_tr_b16 a[168:169], v66 offset:16384
ds_read_b64_tr_b16 a[170:171], v66 offset:16896
ds_read_b64_tr_b16 a[172:173], v67 offset:16384
ds_read_b64_tr_b16 a[174:175], v67 offset:16896
ds_read_b64_tr_b16 a[176:177], v64 offset:24576
ds_read_b64_tr_b16 a[178:179], v64 offset:25088
ds_read_b64_tr_b16 a[180:181], v65 offset:24576
ds_read_b64_tr_b16 a[182:183], v65 offset:25088
ds_read_b64_tr_b16 a[184:185], v66 offset:24576
ds_read_b64_tr_b16 a[186:187], v66 offset:25088
ds_read_b64_tr_b16 a[188:189], v67 offset:24576
ds_read_b64_tr_b16 a[190:191], v67 offset:25088
s_add_u32 s72, s70, 720896
s_add_u32 m0, s71, 49152
s_nop 0
buffer_load_dwordx4 v8, s[32:35], s72 offen offset:0 lds
buffer_load_dwordx4 v9, s[32:35], s72 offen offset:1024 lds
buffer_load_dwordx4 v10, s[32:35], s72 offen offset:2048 lds
buffer_load_dwordx4 v11, s[32:35], s72 offen offset:3072 lds
s_waitcnt lgkmcnt(0)
s_barrier
v_mfma_f32_16x16x32_bf16 v[128:131], v[180:183], a[204:207], v[128:131]
v_add_f32_dpp v120, v121, v120 wave_shr:1 row_mask:0xf bank_mask:0xf bound_ctrl:0
ds_write_b32 v13, v112 offset:5120
v_mfma_f32_16x16x32_bf16 v[128:131], v[176:179], a[208:211], v[128:131]
s_add_u32 s72, s70, 786432
s_add_u32 m0, s71, 65536
v_mfma_f32_16x16x32_bf16 v[128:131], v[172:175], a[212:215], v[128:131]
ds_write_b32 v13, v116 offset:5632
ds_write_b32 v13, v120 offset:6144
v_mfma_f32_16x16x32_bf16 v[128:131], v[168:171], a[216:219], v[128:131]
v_mfma_f32_16x16x32_bf16 v[128:131], v[164:167], a[220:223], v[128:131]
buffer_load_dwordx4 v8, s[32:35], s72 offen offset:0 lds
v_mfma_f32_16x16x32_bf16 v[128:131], v[160:163], a[224:227], v[128:131]
v_mfma_f32_16x16x32_bf16 v[128:131], v[156:159], a[228:231], v[128:131]
v_mfma_f32_16x16x32_bf16 v[128:131], v[152:155], a[232:235], v[128:131]
buffer_load_dwordx4 v9, s[32:35], s72 offen offset:1024 lds
v_mfma_f32_16x16x32_bf16 v[128:131], v[148:151], a[236:239], v[128:131]
v_mfma_f32_16x16x32_bf16 v[128:131], v[144:147], a[240:243], v[128:131]
v_mfma_f32_16x16x32_bf16 v[128:131], v[140:143], a[244:247], v[128:131]
buffer_load_dwordx4 v10, s[32:35], s72 offen offset:2048 lds
v_mfma_f32_16x16x32_bf16 v[128:131], v[136:139], a[248:251], v[128:131]
v_mfma_f32_16x16x32_bf16 v[132:135], v[196:199], a[192:195], 0
v_add_f32_dpp v126, v127, v126 wave_shr:1 row_mask:0xf bank_mask:0xf bound_ctrl:0
v_mfma_f32_16x16x32_bf16 v[132:135], v[192:195], a[196:199], v[132:135]
buffer_load_dwordx4 v11, s[32:35], s72 offen offset:3072 lds
v_mfma_f32_16x16x32_bf16 v[132:135], v[188:191], a[200:203], v[132:135]
v_add_f32_dpp v125, v126, v125 wave_shr:1 row_mask:0xf bank_mask:0xf bound_ctrl:0
v_mfma_f32_16x16x32_bf16 v[132:135], v[184:187], a[204:207], v[132:135]
s_nop 0
v_add_f32_dpp v124, v125, v124 wave_shr:1 row_mask:0xf bank_mask:0xf bound_ctrl:0
ds_write_b32 v13, v124 offset:6656
v_mfma_f32_16x16x32_bf16 v[132:135], v[180:183], a[208:211], v[132:135]
s_add_u32 s72, s70, 851968
s_add_u32 m0, s71, 81920
v_mfma_f32_16x16x32_bf16 v[132:135], v[176:179], a[212:215], v[132:135]
v_mfma_f32_16x16x32_bf16 v[132:135], v[172:175], a[216:219], v[132:135]
v_mfma_f32_16x16x32_bf16 v[132:135], v[168:171], a[220:223], v[132:135]
buffer_load_dwordx4 v8, s[32:35], s72 offen offset:0 lds
v_mfma_f32_16x16x32_bf16 v[132:135], v[164:167], a[224:227], v[132:135]
v_mfma_f32_16x16x32_bf16 v[132:135], v[160:163], a[228:231], v[132:135]
v_mfma_f32_16x16x32_bf16 v[132:135], v[156:159], a[232:235], v[132:135]
buffer_load_dwordx4 v9, s[32:35], s72 offen offset:1024 lds
v_mfma_f32_16x16x32_bf16 v[132:135], v[152:155], a[236:239], v[132:135]
v_mfma_f32_16x16x32_bf16 v[132:135], v[148:151], a[240:243], v[132:135]
v_mfma_f32_16x16x32_bf16 v[132:135], v[144:147], a[244:247], v[132:135]
buffer_load_dwordx4 v10, s[32:35], s72 offen offset:2048 lds
v_mfma_f32_16x16x32_bf16 v[132:135], v[140:143], a[248:251], v[132:135]
v_mfma_f32_16x16x32_bf16 v[132:135], v[136:139], a[252:255], v[132:135]
buffer_load_dwordx4 v11, s[32:35], s72 offen offset:3072 lds
v_add_f32_dpp v130, v131, v130 wave_shr:1 row_mask:0xf bank_mask:0xf bound_ctrl:0
s_nop 5
v_add_f32_dpp v134, v135, v134 wave_shr:1 row_mask:0xf bank_mask:0xf bound_ctrl:0
s_nop 0
v_add_f32_dpp v129, v130, v129 wave_shr:1 row_mask:0xf bank_mask:0xf bound_ctrl:0
s_nop 3
v_add_f32_dpp v133, v134, v133 wave_shr:1 row_mask:0xf bank_mask:0xf bound_ctrl:0
s_nop 0
v_add_f32_dpp v128, v129, v128 wave_shr:1 row_mask:0xf bank_mask:0xf bound_ctrl:0
s_nop 1
v_add_f32_dpp v132, v133, v132 wave_shr:1 row_mask:0xf bank_mask:0xf bound_ctrl:0
ds_write_b32 v13, v128 offset:7168
ds_write_b32 v13, v132 offset:7680
s_mov_b32 exec_lo, 0
s_mov_b32 exec_hi, 0x80000000
ds_write_b128 v14, v[72:75] offset:16
ds_write_b128 v14, v[76:79] offset:48
ds_write_b128 v14, v[80:83] offset:80
ds_write_b128 v14, v[84:87] offset:112
ds_write_b128 v14, v[88:91] offset:144
ds_write_b128 v14, v[92:95] offset:176
ds_write_b128 v14, v[96:99] offset:208
ds_write_b128 v14, v[100:103] offset:240
ds_write_b128 v14, v[104:107] offset:272
ds_write_b128 v14, v[108:111] offset:304
ds_write_b128 v14, v[112:115] offset:336
ds_write_b128 v14, v[116:119] offset:368
ds_write_b128 v14, v[120:123] offset:400
ds_write_b128 v14, v[124:127] offset:432
ds_write_b128 v14, v[128:131] offset:464
ds_write_b128 v14, v[132:135] offset:496
s_mov_b64 exec, -1
v_lshlrev_b32 v63, 16, v63
v_lshlrev_b32 v1, 5, v58
s_lshl_b32 s63, s79, 12
s_add_u32 s3, s67, s63
v_add_u32 v1, s3, v1
s_lshl_b32 s63, s79, 11
s_add_u32 s3, s64, s63
s_add_u32 s3, s3, 131328
v_add_u32 v2, s3, v12
v_lshrrev_b32 v4, 3, v58
v_lshlrev_b32 v4, 4, v4
s_lshl_b32 s63, s79, 8
v_add_u32 v4, s63, v4
v_add_u32 v5, 128, v4
v_and_b32 v6, 7, v0
v_cmp_eq_u32 vcc, 0, v6
s_lshl_b32 s63, s2, 13
s_lshl_b32 s3, s4, 11
v_cndmask_b32 v4, 0, v4, vcc
v_cndmask_b32 v5, 0, v5, vcc
v_add_u32 v4, s66, v4
v_add_u32 v5, s66, v5
s_add_u32 s63, s63, s3
s_add_u32 s63, s63, 15728640
s_waitcnt lgkmcnt(0)
s_barrier
ds_read_b128 v[136:139], v1 offset:0
ds_read_b128 v[140:143], v1 offset:16
ds_read_b128 v[152:155], v2 offset:0
ds_read_b128 v[160:163], v4
ds_read_b128 v[144:147], v1 offset:2048
ds_read_b128 v[148:151], v1 offset:2064
ds_read_b128 v[156:159], v2 offset:1024
ds_read_b128 v[164:167], v5
s_lshl_b32 s65, s5, 6
s_lshl_b32 s3, s4, 4
s_add_u32 s65, s65, s3
v_add_u32 v6, s65, v56
v_lshlrev_b32 v7, 15, v57
v_lshl_add_u32 v70, v6, 4, v7
s_mul_i32 s65, s79, 3670016
s_add_u32 s65, s65, 5242880
v_xor_b32 v71, 256, v70
s_lshr_b32 s66, s5, 1
s_lshl_b32 s66, s66, 7
s_add_u32 s66, s66, 8192
s_lshr_b32 s73, s2, 5
s_lshl_b32 s73, s73, 3
s_and_b32 s3, s2, 7
s_add_u32 s73, s73, s3
s_lshl_b32 s73, s73, 7
s_add_u32 s73, s73, 24576
s_waitcnt lgkmcnt(4)
v_add_f32 v136, v136, v161
v_add_f32 v137, v137, v162
v_add_f32 v138, v138, v163
v_lshlrev_b32 v168, 16, v152
v_and_b32 v169, 0xffff0000, v152
v_lshlrev_b32 v170, 16, v153
v_and_b32 v171, 0xffff0000, v153
v_lshlrev_b32 v172, 16, v154
v_and_b32 v173, 0xffff0000, v154
v_lshlrev_b32 v174, 16, v155
v_and_b32 v175, 0xffff0000, v155
v_fmac_f32 v136, v168, v63
v_fmac_f32 v137, v169, v63
v_fmac_f32 v138, v170, v63
v_fmac_f32 v139, v171, v63
v_fmac_f32 v140, v172, v63
v_fmac_f32 v141, v173, v63
v_fmac_f32 v142, v174, v63
v_fmac_f32 v143, v175, v63
v_cvt_pk_bf16_f32 v152, v136, v137
v_cvt_pk_bf16_f32 v153, v138, v139
v_cvt_pk_bf16_f32 v154, v140, v141
v_cvt_pk_bf16_f32 v155, v142, v143
buffer_store_dwordx4 v[152:155], v12, s[44:47], s63 offen offset:0 sc1
s_waitcnt lgkmcnt(0)
v_add_f32 v144, v144, v165
v_add_f32 v145, v145, v166
v_add_f32 v146, v146, v167
v_lshlrev_b32 v168, 16, v156
v_and_b32 v169, 0xffff0000, v156
v_lshlrev_b32 v170, 16, v157
v_and_b32 v171, 0xffff0000, v157
v_lshlrev_b32 v172, 16, v158
v_and_b32 v173, 0xffff0000, v158
v_lshlrev_b32 v174, 16, v159
v_and_b32 v175, 0xffff0000, v159
v_fmac_f32 v144, v168, v63
v_fmac_f32 v145, v169, v63
v_fmac_f32 v146, v170, v63
v_fmac_f32 v147, v171, v63
v_fmac_f32 v148, v172, v63
v_fmac_f32 v149, v173, v63
v_fmac_f32 v150, v174, v63
v_fmac_f32 v151, v175, v63
v_cvt_pk_bf16_f32 v156, v144, v145
v_cvt_pk_bf16_f32 v157, v146, v147
v_cvt_pk_bf16_f32 v158, v148, v149
v_cvt_pk_bf16_f32 v159, v150, v151
buffer_store_dwordx4 v[156:159], v12, s[44:47], s63 offen offset:1024 sc1
s_cmp_lg_u32 s4, 0
s_cbranch_scc1 L_wf_18
s_mov_b64 exec, 1
s_mov_b32 s3, 0
L_poll_19:
buffer_load_dword v255, v62, s[44:47], s66 offen sc1
s_add_u32 s3, s3, 1
s_cmp_gt_u32 s3, 400000
s_cbranch_scc1 L_pollx_20
s_waitcnt vmcnt(0)
v_cmp_gt_u32 vcc, 16, v255
s_cbranch_vccnz L_poll_19
L_pollx_20:
s_waitcnt vmcnt(0)
s_mov_b64 exec, -1
L_wf_18:
s_barrier
buffer_load_dwordx4 v[200:203], v71, s[44:47], s65 offen sc1
buffer_load_dwordx4 v[196:199], v70, s[44:47], s65 offen sc1
s_add_u32 s65, s65, 131072
buffer_load_dwordx4 v[208:211], v71, s[44:47], s65 offen sc1
buffer_load_dwordx4 v[204:207], v70, s[44:47], s65 offen sc1
s_add_u32 s65, s65, 131072
buffer_load_dwordx4 v[216:219], v71, s[44:47], s65 offen sc1
buffer_load_dwordx4 v[212:215], v70, s[44:47], s65 offen sc1
s_add_u32 s65, s65, 131072
buffer_load_dwordx4 v[224:227], v71, s[44:47], s65 offen sc1
buffer_load_dwordx4 v[220:223], v70, s[44:47], s65 offen sc1
s_add_u32 s65, s65, 131072
buffer_load_dwordx4 v[232:235], v71, s[44:47], s65 offen sc1
buffer_load_dwordx4 v[228:231], v70, s[44:47], s65 offen sc1
s_add_u32 s65, s65, 131072
s_waitcnt vmcnt(10)
s_barrier
s_cmp_lg_u32 s4, 0
s_cbranch_scc1 L_sig_21
s_mov_b64 exec, 1
v_mov_b32 v255, 1
buffer_atomic_add v255, v62, s[44:47], s73 offen sc1
s_mov_b64 exec, -1
L_sig_21:
v_lshlrev_b32 v136, 16, v48
v_and_b32 v137, 0xffff0000, v48
v_lshlrev_b32 v138, 16, v49
v_and_b32 v139, 0xffff0000, v49
v_lshlrev_b32 v140, 16, v50
v_and_b32 v141, 0xffff0000, v50
v_lshlrev_b32 v142, 16, v51
v_and_b32 v143, 0xffff0000, v51
v_lshlrev_b32 v144, 16, v52
v_and_b32 v145, 0xffff0000, v52
v_lshlrev_b32 v146, 16, v53
v_and_b32 v147, 0xffff0000, v53
v_lshlrev_b32 v148, 16, v54
v_and_b32 v149, 0xffff0000, v54
v_lshlrev_b32 v150, 16, v55
v_and_b32 v151, 0xffff0000, v55
s_waitcnt vmcnt(8)
v_mfma_f32_16x16x32_bf16 v[88:91], a[0:3], v[200:203], 0
buffer_load_dwordx4 v[240:243], v71, s[44:47], s65 offen sc1
v_mfma_f32_16x16x32_bf16 v[72:75], a[0:3], v[196:199], 0
s_lshl_b32 s66, s6, 10
s_add_u32 s66, s66, 24576
v_mfma_f32_16x16x32_bf16 v[92:95], a[4:7], v[200:203], 0
buffer_load_dwordx4 v[236:239], v70, s[44:47], s65 offen sc1
s_add_u32 s65, s65, 131072
v_mfma_f32_16x16x32_bf16 v[76:79], a[4:7], v[196:199], 0
v_lshrrev_b32 v1, 3, v58
v_and_b32 v2, 7, v0
v_mfma_f32_16x16x32_bf16 v[96:99], a[8:11], v[200:203], 0
v_and_b32 v3, 6, v1
v_xor_b32 v2, v2, v3
v_mfma_f32_16x16x32_bf16 v[80:83], a[8:11], v[196:199], 0
v_lshlrev_b32 v1, 12, v1
v_lshl_add_u32 v7, v2, 4, v1
v_mfma_f32_16x16x32_bf16 v[100:103], a[12:15], v[200:203], 0
s_lshl_b32 s67, s6, 18
s_lshl_b32 s3, s4, 16
v_mfma_f32_16x16x32_bf16 v[84:87], a[12:15], v[196:199], 0
s_add_u32 s67, s67, s3
s_lshl_b32 s3, s5, 7
s_waitcnt vmcnt(8)
v_mfma_f32_16x16x32_bf16 v[88:91], a[16:19], v[208:211], v[88:91]
buffer_load_dwordx4 v[200:203], v71, s[44:47], s65 offen sc1
v_mfma_f32_16x16x32_bf16 v[72:75], a[16:19], v[204:207], v[72:75]
s_add_u32 s67, s67, s3
s_add_u32 s67, s67, 15728640
v_mfma_f32_16x16x32_bf16 v[92:95], a[20:23], v[208:211], v[92:95]
buffer_load_dwordx4 v[196:199], v70, s[44:47], s65 offen sc1
s_add_u32 s65, s65, 131072
v_mfma_f32_16x16x32_bf16 v[76:79], a[20:23], v[204:207], v[76:79]
s_lshl_b32 s68, s4, 11
s_add_u32 s69, s68, 131072
v_mfma_f32_16x16x32_bf16 v[96:99], a[24:27], v[208:211], v[96:99]
v_lshl_add_u32 v3, v57, 2, v59
v_and_b32 v4, 6, v3
v_mfma_f32_16x16x32_bf16 v[80:83], a[24:27], v[204:207], v[80:83]
v_lshrrev_b32 v1, 1, v60
s_lshl_b32 s3, s4, 1
v_mfma_f32_16x16x32_bf16 v[100:103], a[28:31], v[208:211], v[100:103]
v_add_u32 v1, s3, v1
v_xor_b32 v4, v4, v1
v_mfma_f32_16x16x32_bf16 v[84:87], a[28:31], v[204:207], v[84:87]
v_lshlrev_b32 v4, 4, v4
v_and_b32 v1, 1, v60
s_waitcnt vmcnt(8)
v_mfma_f32_16x16x32_bf16 v[88:91], a[32:35], v[216:219], v[88:91]
buffer_load_dwordx4 v[208:211], v71, s[44:47], s65 offen sc1
v_mfma_f32_16x16x32_bf16 v[72:75], a[32:35], v[212:215], v[72:75]
v_lshl_or_b32 v4, v1, 3, v4
v_lshl_add_u32 v3, v3, 7, v4
v_mfma_f32_16x16x32_bf16 v[92:95], a[36:39], v[216:219], v[92:95]
buffer_load_dwordx4 v[204:207], v70, s[44:47], s65 offen sc1
s_add_u32 s65, s65, 131072
v_mfma_f32_16x16x32_bf16 v[76:79], a[36:39], v[212:215], v[76:79]
v_add_u32 v3, 131072, v3
s_lshl_b32 s3, s4, 12
v_mfma_f32_16x16x32_bf16 v[96:99], a[40:43], v[216:219], v[96:99]
s_add_u32 s3, s3, 139264
v_add_u32 v13, s3, v12
v_mfma_f32_16x16x32_bf16 v[80:83], a[40:43], v[212:215], v[80:83]
v_xor_b32 v14, 4096, v13
v_lshrrev_b32 v1, 1, v57
v_mfma_f32_16x16x32_bf16 v[100:103], a[44:47], v[216:219], v[100:103]
v_and_b32 v2, 7, v56
v_xor_b32 v1, v1, v2
v_mfma_f32_16x16x32_bf16 v[84:87], a[44:47], v[212:215], v[84:87]
v_lshlrev_b32 v1, 4, v1
v_and_b32 v2, 1, v57
s_waitcnt vmcnt(8)
v_mfma_f32_16x16x32_bf16 v[88:91], a[48:51], v[224:227], v[88:91]
buffer_load_dwordx4 v[216:219], v71, s[44:47], s65 offen sc1
v_mfma_f32_16x16x32_bf16 v[72:75], a[48:51], v[220:223], v[72:75]
v_lshl_or_b32 v1, v2, 3, v1
v_lshl_add_u32 v1, v56, 7, v1
v_mfma_f32_16x16x32_bf16 v[92:95], a[52:55], v[224:227], v[92:95]
buffer_load_dwordx4 v[212:215], v70, s[44:47], s65 offen sc1
s_add_u32 s65, s65, 131072
v_mfma_f32_16x16x32_bf16 v[76:79], a[52:55], v[220:223], v[76:79]
s_add_u32 s3, s68, 155648
v_add_u32 v8, s3, v1
v_mfma_f32_16x16x32_bf16 v[96:99], a[56:59], v[224:227], v[96:99]
v_xor_b32 v9, 32, v8
v_xor_b32 v10, 64, v8
v_mfma_f32_16x16x32_bf16 v[80:83], a[56:59], v[220:223], v[80:83]
v_xor_b32 v11, 96, v8
v_lshrrev_b32 v1, 3, v58
v_mfma_f32_16x16x32_bf16 v[100:103], a[60:63], v[224:227], v[100:103]
v_and_b32 v2, 7, v0
v_xor_b32 v5, v1, v2
v_mfma_f32_16x16x32_bf16 v[84:87], a[60:63], v[220:223], v[84:87]
v_lshlrev_b32 v5, 4, v5
v_lshl_add_u32 v5, v1, 7, v5
s_waitcnt vmcnt(8)
v_mfma_f32_16x16x32_bf16 v[88:91], a[64:67], v[232:235], v[88:91]
buffer_load_dwordx4 v[224:227], v71, s[44:47], s65 offen sc1
v_mfma_f32_16x16x32_bf16 v[72:75], a[64:67], v[228:231], v[72:75]
v_add_u32 v5, s3, v5
v_lshlrev_b32 v1, 10, v1
v_mfma_f32_16x16x32_bf16 v[92:95], a[68:71], v[232:235], v[92:95]
buffer_load_dwordx4 v[220:223], v70, s[44:47], s65 offen sc1
s_add_u32 s65, s65, 131072
v_mfma_f32_16x16x32_bf16 v[76:79], a[68:71], v[228:231], v[76:79]
v_lshl_add_u32 v6, v2, 4, v1
s_lshl_b32 s64, s5, 16
v_mfma_f32_16x16x32_bf16 v[96:99], a[72:75], v[232:235], v[96:99]
s_lshl_b32 s3, s4, 14
s_add_u32 s64, s64, s3
v_mfma_f32_16x16x32_bf16 v[80:83], a[72:75], v[228:231], v[80:83]
s_lshl_b32 s3, s6, 7
s_add_u32 s64, s64, s3
v_mfma_f32_16x16x32_bf16 v[100:103], a[76:79], v[232:235], v[100:103]
s_add_u32 s63, s64, 8192
v_mov_b32 v192, 0xbfb8aa3b
v_mfma_f32_16x16x32_bf16 v[84:87], a[76:79], v[228:231], v[84:87]
v_mov_b32 v193, 0xbfb8aa3b
v_mov_b32 v194, 1.0
s_waitcnt vmcnt(8)
v_mfma_f32_16x16x32_bf16 v[88:91], a[80:83], v[240:243], v[88:91]
buffer_load_dwordx4 v[232:235], v71, s[44:47], s65 offen sc1
v_mfma_f32_16x16x32_bf16 v[72:75], a[80:83], v[236:239], v[72:75]
v_mov_b32 v195, 1.0
v_mfma_f32_16x16x32_bf16 v[92:95], a[84:87], v[240:243], v[92:95]
buffer_load_dwordx4 v[228:231], v70, s[44:47], s65 offen sc1
s_add_u32 s65, s65, 131072
v_mfma_f32_16x16x32_bf16 v[76:79], a[84:87], v[236:239], v[76:79]
v_mfma_f32_16x16x32_bf16 v[96:99], a[88:91], v[240:243], v[96:99]
v_mfma_f32_16x16x32_bf16 v[80:83], a[88:91], v[236:239], v[80:83]
v_mfma_f32_16x16x32_bf16 v[100:103], a[92:95], v[240:243], v[100:103]
v_mfma_f32_16x16x32_bf16 v[84:87], a[92:95], v[236:239], v[84:87]
s_waitcnt vmcnt(8)
v_mfma_f32_16x16x32_bf16 v[88:91], a[96:99], v[200:203], v[88:91]
buffer_load_dwordx4 v[240:243], v71, s[44:47], s65 offen sc1
v_mfma_f32_16x16x32_bf16 v[72:75], a[96:99], v[196:199], v[72:75]
v_mfma_f32_16x16x32_bf16 v[92:95], a[100:103], v[200:203], v[92:95]
buffer_load_dwordx4 v[236:239], v70, s[44:47], s65 offen sc1
s_add_u32 s65, s65, 131072
v_mfma_f32_16x16x32_bf16 v[76:79], a[100:103], v[196:199], v[76:79]
v_mfma_f32_16x16x32_bf16 v[96:99], a[104:107], v[200:203], v[96:99]
v_mfma_f32_16x16x32_bf16 v[80:83], a[104:107], v[196:199], v[80:83]
v_mfma_f32_16x16x32_bf16 v[100:103], a[108:111], v[200:203], v[100:103]
v_mfma_f32_16x16x32_bf16 v[84:87], a[108:111], v[196:199], v[84:87]
s_waitcnt vmcnt(8)
v_mfma_f32_16x16x32_bf16 v[88:91], a[112:115], v[208:211], v[88:91]
buffer_load_dwordx4 v[200:203], v71, s[44:47], s65 offen sc1
v_mfma_f32_16x16x32_bf16 v[72:75], a[112:115], v[204:207], v[72:75]
v_mfma_f32_16x16x32_bf16 v[92:95], a[116:119], v[208:211], v[92:95]
buffer_load_dwordx4 v[196:199], v70, s[44:47], s65 offen sc1
s_add_u32 s65, s65, 131072
v_mfma_f32_16x16x32_bf16 v[76:79], a[116:119], v[204:207], v[76:79]
v_mfma_f32_16x16x32_bf16 v[96:99], a[120:123], v[208:211], v[96:99]
v_mfma_f32_16x16x32_bf16 v[80:83], a[120:123], v[204:207], v[80:83]
v_mfma_f32_16x16x32_bf16 v[100:103], a[124:127], v[208:211], v[100:103]
v_mfma_f32_16x16x32_bf16 v[84:87], a[124:127], v[204:207], v[84:87]
s_waitcnt vmcnt(8)
v_mfma_f32_16x16x32_bf16 v[88:91], a[128:131], v[216:219], v[88:91]
buffer_load_dwordx4 v[208:211], v71, s[44:47], s65 offen sc1
v_mfma_f32_16x16x32_bf16 v[72:75], a[128:131], v[212:215], v[72:75]
v_mfma_f32_16x16x32_bf16 v[92:95], a[132:135], v[216:219], v[92:95]
buffer_load_dwordx4 v[204:207], v70, s[44:47], s65 offen sc1
s_add_u32 s65, s65, 131072
v_mfma_f32_16x16x32_bf16 v[76:79], a[132:135], v[212:215], v[76:79]
v_mfma_f32_16x16x32_bf16 v[96:99], a[136:139], v[216:219], v[96:99]
v_mfma_f32_16x16x32_bf16 v[80:83], a[136:139], v[212:215], v[80:83]
v_mfma_f32_16x16x32_bf16 v[100:103], a[140:143], v[216:219], v[100:103]
v_mfma_f32_16x16x32_bf16 v[84:87], a[140:143], v[212:215], v[84:87]
s_waitcnt vmcnt(8)
v_mfma_f32_16x16x32_bf16 v[88:91], a[144:147], v[224:227], v[88:91]
buffer_load_dwordx4 v[216:219], v71, s[44:47], s65 offen sc1
v_mfma_f32_16x16x32_bf16 v[72:75], a[144:147], v[220:223], v[72:75]
v_mfma_f32_16x16x32_bf16 v[92:95], a[148:151], v[224:227], v[92:95]
buffer_load_dwordx4 v[212:215], v70, s[44:47], s65 offen sc1
s_add_u32 s65, s65, 131072
v_mfma_f32_16x16x32_bf16 v[76:79], a[148:151], v[220:223], v[76:79]
v_mfma_f32_16x16x32_bf16 v[96:99], a[152:155], v[224:227], v[96:99]
v_mfma_f32_16x16x32_bf16 v[80:83], a[152:155], v[220:223], v[80:83]
v_mfma_f32_16x16x32_bf16 v[100:103], a[156:159], v[224:227], v[100:103]
v_mfma_f32_16x16x32_bf16 v[84:87], a[156:159], v[220:223], v[84:87]
s_waitcnt vmcnt(8)
v_mfma_f32_16x16x32_bf16 v[88:91], a[160:163], v[232:235], v[88:91]
buffer_load_dwordx4 v[224:227], v71, s[44:47], s65 offen sc1
v_mfma_f32_16x16x32_bf16 v[72:75], a[160:163], v[228:231], v[72:75]
v_mfma_f32_16x16x32_bf16 v[92:95], a[164:167], v[232:235], v[92:95]
buffer_load_dwordx4 v[220:223], v70, s[44:47], s65 offen sc1
s_add_u32 s65, s65, 131072
v_mfma_f32_16x16x32_bf16 v[76:79], a[164:167], v[228:231], v[76:79]
v_mfma_f32_16x16x32_bf16 v[96:99], a[168:171], v[232:235], v[96:99]
v_mfma_f32_16x16x32_bf16 v[80:83], a[168:171], v[228:231], v[80:83]
v_mfma_f32_16x16x32_bf16 v[100:103], a[172:175], v[232:235], v[100:103]
v_mfma_f32_16x16x32_bf16 v[84:87], a[172:175], v[228:231], v[84:87]
s_waitcnt vmcnt(8)
v_mfma_f32_16x16x32_bf16 v[88:91], a[176:179], v[240:243], v[88:91]
ds_read_b64_tr_b16 v[104:105], v64 offset:32768
ds_read_b64_tr_b16 v[106:107], v64 offset:33280
v_mfma_f32_16x16x32_bf16 v[72:75], a[176:179], v[236:239], v[72:75]
ds_read_b64_tr_b16 v[108:109], v65 offset:32768
ds_read_b64_tr_b16 v[110:111], v65 offset:33280
v_mfma_f32_16x16x32_bf16 v[92:95], a[180:183], v[240:243], v[92:95]
ds_read_b64_tr_b16 v[112:113], v66 offset:32768
ds_read_b64_tr_b16 v[114:115], v66 offset:33280
v_mfma_f32_16x16x32_bf16 v[76:79], a[180:183], v[236:239], v[76:79]
ds_read_b64_tr_b16 v[116:117], v67 offset:32768
ds_read_b64_tr_b16 v[118:119], v67 offset:33280
v_mfma_f32_16x16x32_bf16 v[96:99], a[184:187], v[240:243], v[96:99]
buffer_load_dwordx4 v[232:235], v71, s[44:47], s65 offen sc1
v_mfma_f32_16x16x32_bf16 v[80:83], a[184:187], v[236:239], v[80:83]
v_mfma_f32_16x16x32_bf16 v[100:103], a[188:191], v[240:243], v[100:103]
buffer_load_dwordx4 v[228:231], v70, s[44:47], s65 offen sc1
s_add_u32 s65, s65, 131072
v_mfma_f32_16x16x32_bf16 v[84:87], a[188:191], v[236:239], v[84:87]
s_waitcnt vmcnt(8)
s_waitcnt lgkmcnt(0)
v_mfma_f32_16x16x32_bf16 v[88:91], v[104:107], v[200:203], v[88:91]
ds_read_b64_tr_b16 v[120:121], v64 offset:40960
ds_read_b64_tr_b16 v[122:123], v64 offset:41472
v_mfma_f32_16x16x32_bf16 v[72:75], v[104:107], v[196:199], v[72:75]
ds_read_b64_tr_b16 v[124:125], v65 offset:40960
ds_read_b64_tr_b16 v[126:127], v65 offset:41472
v_mfma_f32_16x16x32_bf16 v[92:95], v[108:111], v[200:203], v[92:95]
ds_read_b64_tr_b16 v[128:129], v66 offset:40960
ds_read_b64_tr_b16 v[130:131], v66 offset:41472
v_mfma_f32_16x16x32_bf16 v[76:79], v[108:111], v[196:199], v[76:79]
ds_read_b64_tr_b16 v[132:133], v67 offset:40960
ds_read_b64_tr_b16 v[134:135], v67 offset:41472
v_mfma_f32_16x16x32_bf16 v[96:99], v[112:115], v[200:203], v[96:99]
buffer_load_dwordx4 v[240:243], v71, s[44:47], s65 offen sc1
v_mfma_f32_16x16x32_bf16 v[80:83], v[112:115], v[196:199], v[80:83]
v_mfma_f32_16x16x32_bf16 v[100:103], v[116:119], v[200:203], v[100:103]
buffer_load_dwordx4 v[236:239], v70, s[44:47], s65 offen sc1
s_add_u32 s65, s65, 131072
v_mfma_f32_16x16x32_bf16 v[84:87], v[116:119], v[196:199], v[84:87]
s_waitcnt vmcnt(8)
s_waitcnt lgkmcnt(0)
v_mfma_f32_16x16x32_bf16 v[88:91], v[120:123], v[208:211], v[88:91]
ds_read_b64_tr_b16 v[104:105], v64 offset:49152
ds_read_b64_tr_b16 v[106:107], v64 offset:49664
v_mfma_f32_16x16x32_bf16 v[72:75], v[120:123], v[204:207], v[72:75]
ds_read_b64_tr_b16 v[108:109], v65 offset:49152
ds_read_b64_tr_b16 v[110:111], v65 offset:49664
v_mfma_f32_16x16x32_bf16 v[92:95], v[124:127], v[208:211], v[92:95]
ds_read_b64_tr_b16 v[112:113], v66 offset:49152
ds_read_b64_tr_b16 v[114:115], v66 offset:49664
v_mfma_f32_16x16x32_bf16 v[76:79], v[124:127], v[204:207], v[76:79]
ds_read_b64_tr_b16 v[116:117], v67 offset:49152
ds_read_b64_tr_b16 v[118:119], v67 offset:49664
v_mfma_f32_16x16x32_bf16 v[96:99], v[128:131], v[208:211], v[96:99]
buffer_load_dwordx4 v[200:203], v71, s[44:47], s65 offen sc1
v_mfma_f32_16x16x32_bf16 v[80:83], v[128:131], v[204:207], v[80:83]
v_mfma_f32_16x16x32_bf16 v[100:103], v[132:135], v[208:211], v[100:103]
buffer_load_dwordx4 v[196:199], v70, s[44:47], s65 offen sc1
s_add_u32 s65, s65, 131072
v_mfma_f32_16x16x32_bf16 v[84:87], v[132:135], v[204:207], v[84:87]
s_mov_b64 exec, 0xff
buffer_load_dword v254, v252, s[44:47], s66 offen sc1
s_mov_b64 exec, -1
s_waitcnt vmcnt(9)
s_waitcnt lgkmcnt(0)
v_mfma_f32_16x16x32_bf16 v[88:91], v[104:107], v[216:219], v[88:91]
ds_read_b64_tr_b16 v[120:121], v64 offset:57344
ds_read_b64_tr_b16 v[122:123], v64 offset:57856
v_mfma_f32_16x16x32_bf16 v[72:75], v[104:107], v[212:215], v[72:75]
ds_read_b64_tr_b16 v[124:125], v65 offset:57344
ds_read_b64_tr_b16 v[126:127], v65 offset:57856
v_mfma_f32_16x16x32_bf16 v[92:95], v[108:111], v[216:219], v[92:95]
ds_read_b64_tr_b16 v[128:129], v66 offset:57344
ds_read_b64_tr_b16 v[130:131], v66 offset:57856
v_mfma_f32_16x16x32_bf16 v[76:79], v[108:111], v[212:215], v[76:79]
ds_read_b64_tr_b16 v[132:133], v67 offset:57344
ds_read_b64_tr_b16 v[134:135], v67 offset:57856
v_mfma_f32_16x16x32_bf16 v[96:99], v[112:115], v[216:219], v[96:99]
buffer_load_dwordx4 v[208:211], v71, s[44:47], s65 offen sc1
v_mfma_f32_16x16x32_bf16 v[80:83], v[112:115], v[212:215], v[80:83]
v_mfma_f32_16x16x32_bf16 v[100:103], v[116:119], v[216:219], v[100:103]
buffer_load_dwordx4 v[204:207], v70, s[44:47], s65 offen sc1
s_add_u32 s65, s65, 131072
v_mfma_f32_16x16x32_bf16 v[84:87], v[116:119], v[212:215], v[84:87]
s_waitcnt vmcnt(9)
s_waitcnt lgkmcnt(0)
v_mfma_f32_16x16x32_bf16 v[88:91], v[120:123], v[224:227], v[88:91]
v_subrev_u32 v64, 65536, v64
v_subrev_u32 v65, 65536, v65
v_mfma_f32_16x16x32_bf16 v[72:75], v[120:123], v[220:223], v[72:75]
v_subrev_u32 v66, 65536, v66
v_subrev_u32 v67, 65536, v67
v_mfma_f32_16x16x32_bf16 v[92:95], v[124:127], v[224:227], v[92:95]
ds_read_b64_tr_b16 v[104:105], v64 offset:0
ds_read_b64_tr_b16 v[106:107], v64 offset:512
v_mfma_f32_16x16x32_bf16 v[76:79], v[124:127], v[220:223], v[76:79]
ds_read_b64_tr_b16 v[108:109], v65 offset:0
ds_read_b64_tr_b16 v[110:111], v65 offset:512
v_mfma_f32_16x16x32_bf16 v[96:99], v[128:131], v[224:227], v[96:99]
buffer_load_dwordx4 v[216:219], v71, s[44:47], s65 offen sc1
v_mfma_f32_16x16x32_bf16 v[80:83], v[128:131], v[220:223], v[80:83]
ds_read_b64_tr_b16 v[112:113], v66 offset:0
ds_read_b64_tr_b16 v[114:115], v66 offset:512
v_mfma_f32_16x16x32_bf16 v[100:103], v[132:135], v[224:227], v[100:103]
buffer_load_dwordx4 v[212:215], v70, s[44:47], s65 offen sc1
s_add_u32 s65, s65, 131072
v_mfma_f32_16x16x32_bf16 v[84:87], v[132:135], v[220:223], v[84:87]
ds_read_b64_tr_b16 v[116:117], v67 offset:0
ds_read_b64_tr_b16 v[118:119], v67 offset:512
s_waitcnt vmcnt(9)
s_waitcnt lgkmcnt(0)
v_mfma_f32_16x16x32_bf16 v[88:91], v[104:107], v[232:235], v[88:91]
ds_read_b64_tr_b16 v[120:121], v64 offset:8192
ds_read_b64_tr_b16 v[122:123], v64 offset:8704
v_mfma_f32_16x16x32_bf16 v[72:75], v[104:107], v[228:231], v[72:75]
ds_read_b64_tr_b16 v[124:125], v65 offset:8192
ds_read_b64_tr_b16 v[126:127], v65 offset:8704
v_mfma_f32_16x16x32_bf16 v[92:95], v[108:111], v[232:235], v[92:95]
ds_read_b64_tr_b16 v[128:129], v66 offset:8192
ds_read_b64_tr_b16 v[130:131], v66 offset:8704
v_mfma_f32_16x16x32_bf16 v[76:79], v[108:111], v[228:231], v[76:79]
ds_read_b64_tr_b16 v[132:133], v67 offset:8192
ds_read_b64_tr_b16 v[134:135], v67 offset:8704
v_mfma_f32_16x16x32_bf16 v[96:99], v[112:115], v[232:235], v[96:99]
buffer_load_dwordx4 v[224:227], v71, s[44:47], s65 offen sc1
v_mfma_f32_16x16x32_bf16 v[80:83], v[112:115], v[228:231], v[80:83]
v_mfma_f32_16x16x32_bf16 v[100:103], v[116:119], v[232:235], v[100:103]
buffer_load_dwordx4 v[220:223], v70, s[44:47], s65 offen sc1
s_add_u32 s65, s65, 131072
v_mfma_f32_16x16x32_bf16 v[84:87], v[116:119], v[228:231], v[84:87]
s_waitcnt vmcnt(9)
s_waitcnt lgkmcnt(0)
v_mfma_f32_16x16x32_bf16 v[88:91], v[120:123], v[240:243], v[88:91]
ds_read_b64_tr_b16 v[104:105], v64 offset:16384
ds_read_b64_tr_b16 v[106:107], v64 offset:16896
v_mfma_f32_16x16x32_bf16 v[72:75], v[120:123], v[236:239], v[72:75]
ds_read_b64_tr_b16 v[108:109], v65 offset:16384
ds_read_b64_tr_b16 v[110:111], v65 offset:16896
v_mfma_f32_16x16x32_bf16 v[92:95], v[124:127], v[240:243], v[92:95]
ds_read_b64_tr_b16 v[112:113], v66 offset:16384
ds_read_b64_tr_b16 v[114:115], v66 offset:16896
v_mfma_f32_16x16x32_bf16 v[76:79], v[124:127], v[236:239], v[76:79]
ds_read_b64_tr_b16 v[116:117], v67 offset:16384
ds_read_b64_tr_b16 v[118:119], v67 offset:16896
v_mfma_f32_16x16x32_bf16 v[96:99], v[128:131], v[240:243], v[96:99]
buffer_load_dwordx4 v[232:235], v71, s[44:47], s65 offen sc1
v_mfma_f32_16x16x32_bf16 v[80:83], v[128:131], v[236:239], v[80:83]
v_mfma_f32_16x16x32_bf16 v[100:103], v[132:135], v[240:243], v[100:103]
buffer_load_dwordx4 v[228:231], v70, s[44:47], s65 offen sc1
s_add_u32 s65, s65, 131072
v_mfma_f32_16x16x32_bf16 v[84:87], v[132:135], v[236:239], v[84:87]
s_waitcnt vmcnt(9)
s_waitcnt lgkmcnt(0)
v_mfma_f32_16x16x32_bf16 v[88:91], v[104:107], v[200:203], v[88:91]
ds_read_b64_tr_b16 v[120:121], v64 offset:24576
ds_read_b64_tr_b16 v[122:123], v64 offset:25088
v_mfma_f32_16x16x32_bf16 v[72:75], v[104:107], v[196:199], v[72:75]
ds_read_b64_tr_b16 v[124:125], v65 offset:24576
ds_read_b64_tr_b16 v[126:127], v65 offset:25088
v_mfma_f32_16x16x32_bf16 v[92:95], v[108:111], v[200:203], v[92:95]
ds_read_b64_tr_b16 v[128:129], v66 offset:24576
ds_read_b64_tr_b16 v[130:131], v66 offset:25088
v_mfma_f32_16x16x32_bf16 v[76:79], v[108:111], v[196:199], v[76:79]
ds_read_b64_tr_b16 v[132:133], v67 offset:24576
ds_read_b64_tr_b16 v[134:135], v67 offset:25088
v_mfma_f32_16x16x32_bf16 v[96:99], v[112:115], v[200:203], v[96:99]
buffer_load_dwordx4 v[240:243], v71, s[44:47], s65 offen sc1
v_mfma_f32_16x16x32_bf16 v[80:83], v[112:115], v[196:199], v[80:83]
v_mfma_f32_16x16x32_bf16 v[100:103], v[116:119], v[200:203], v[100:103]
buffer_load_dwordx4 v[236:239], v70, s[44:47], s65 offen sc1
s_add_u32 s65, s65, 131072
v_mfma_f32_16x16x32_bf16 v[84:87], v[116:119], v[196:199], v[84:87]
s_waitcnt vmcnt(8)
s_waitcnt lgkmcnt(0)
s_mov_b64 exec, 0xff
v_cmp_gt_u32 vcc, 4, v254
s_mov_b64 exec, -1
s_cbranch_vccz L_ck_22
s_mov_b64 exec, 0xff
s_mov_b32 s3, 0
L_poll_23:
buffer_load_dword v255, v252, s[44:47], s66 offen sc1
s_add_u32 s3, s3, 1
s_cmp_gt_u32 s3, 400000
s_cbranch_scc1 L_pollx_24
s_waitcnt vmcnt(0)
v_cmp_gt_u32 vcc, 4, v255
s_cbranch_vccnz L_poll_23
L_pollx_24:
s_waitcnt vmcnt(0)
s_mov_b64 exec, -1
L_ck_22:
v_mfma_f32_16x16x32_bf16 v[88:91], v[120:123], v[208:211], v[88:91]
ds_read_b64_tr_b16 v[104:105], v64 offset:32768
ds_read_b64_tr_b16 v[106:107], v64 offset:33280
v_mfma_f32_16x16x32_bf16 v[72:75], v[120:123], v[204:207], v[72:75]
ds_read_b64_tr_b16 v[108:109], v65 offset:32768
ds_read_b64_tr_b16 v[110:111], v65 offset:33280
v_mfma_f32_16x16x32_bf16 v[92:95], v[124:127], v[208:211], v[92:95]
ds_read_b64_tr_b16 v[112:113], v66 offset:32768
ds_read_b64_tr_b16 v[114:115], v66 offset:33280
v_mfma_f32_16x16x32_bf16 v[76:79], v[124:127], v[204:207], v[76:79]
ds_read_b64_tr_b16 v[116:117], v67 offset:32768
ds_read_b64_tr_b16 v[118:119], v67 offset:33280
v_mfma_f32_16x16x32_bf16 v[96:99], v[128:131], v[208:211], v[96:99]
buffer_load_dwordx4 v[200:203], v71, s[44:47], s65 offen sc1
v_mfma_f32_16x16x32_bf16 v[80:83], v[128:131], v[204:207], v[80:83]
buffer_load_dwordx4 v[196:199], v70, s[44:47], s65 offen sc1
s_add_u32 s65, s65, 131072
v_mfma_f32_16x16x32_bf16 v[100:103], v[132:135], v[208:211], v[100:103]
s_mov_b32 m0, s69
s_add_u32 s3, s67, 31744
buffer_load_dwordx4 v7, s[44:47], s67 offen sc1 lds
v_mfma_f32_16x16x32_bf16 v[84:87], v[132:135], v[204:207], v[84:87]
buffer_load_dwordx4 v7, s[44:47], s3 offen offset:1024 sc1 lds
s_waitcnt vmcnt(10)
s_waitcnt lgkmcnt(0)
v_mfma_f32_16x16x32_bf16 v[88:91], v[104:107], v[216:219], v[88:91]
ds_read_b64_tr_b16 v[120:121], v64 offset:40960
ds_read_b64_tr_b16 v[122:123], v64 offset:41472
v_mfma_f32_16x16x32_bf16 v[72:75], v[104:107], v[212:215], v[72:75]
ds_read_b64_tr_b16 v[124:125], v65 offset:40960
ds_read_b64_tr_b16 v[126:127], v65 offset:41472
v_mfma_f32_16x16x32_bf16 v[92:95], v[108:111], v[216:219], v[92:95]
ds_read_b64_tr_b16 v[128:129], v66 offset:40960
ds_read_b64_tr_b16 v[130:131], v66 offset:41472
v_mfma_f32_16x16x32_bf16 v[76:79], v[108:111], v[212:215], v[76:79]
ds_read_b64_tr_b16 v[132:133], v67 offset:40960
ds_read_b64_tr_b16 v[134:135], v67 offset:41472
v_mfma_f32_16x16x32_bf16 v[96:99], v[112:115], v[216:219], v[96:99]
buffer_load_dwordx4 v[208:211], v71, s[44:47], s65 offen sc1
v_mfma_f32_16x16x32_bf16 v[80:83], v[112:115], v[212:215], v[80:83]
v_mfma_f32_16x16x32_bf16 v[100:103], v[116:119], v[216:219], v[100:103]
buffer_load_dwordx4 v[204:207], v70, s[44:47], s65 offen sc1
s_add_u32 s65, s65, 131072
v_mfma_f32_16x16x32_bf16 v[84:87], v[116:119], v[212:215], v[84:87]
s_waitcnt vmcnt(10)
s_waitcnt lgkmcnt(0)
v_mfma_f32_16x16x32_bf16 v[88:91], v[120:123], v[224:227], v[88:91]
ds_read_b64_tr_b16 v[104:105], v64 offset:49152
ds_read_b64_tr_b16 v[106:107], v64 offset:49664
v_mfma_f32_16x16x32_bf16 v[72:75], v[120:123], v[220:223], v[72:75]
ds_read_b64_tr_b16 v[108:109], v65 offset:49152
ds_read_b64_tr_b16 v[110:111], v65 offset:49664
v_mfma_f32_16x16x32_bf16 v[92:95], v[124:127], v[224:227], v[92:95]
ds_read_b64_tr_b16 v[112:113], v66 offset:49152
ds_read_b64_tr_b16 v[114:115], v66 offset:49664
v_mfma_f32_16x16x32_bf16 v[76:79], v[124:127], v[220:223], v[76:79]
ds_read_b64_tr_b16 v[116:117], v67 offset:49152
ds_read_b64_tr_b16 v[118:119], v67 offset:49664
v_mfma_f32_16x16x32_bf16 v[96:99], v[128:131], v[224:227], v[96:99]
buffer_load_dwordx4 v[216:219], v71, s[44:47], s65 offen sc1
v_mfma_f32_16x16x32_bf16 v[80:83], v[128:131], v[220:223], v[80:83]
v_mfma_f32_16x16x32_bf16 v[100:103], v[132:135], v[224:227], v[100:103]
buffer_load_dwordx4 v[212:215], v70, s[44:47], s65 offen sc1
s_add_u32 s65, s65, 131072
v_mfma_f32_16x16x32_bf16 v[84:87], v[132:135], v[220:223], v[84:87]
s_waitcnt vmcnt(10)
s_waitcnt lgkmcnt(0)
v_mfma_f32_16x16x32_bf16 v[88:91], v[104:107], v[232:235], v[88:91]
ds_read_b64_tr_b16 v[120:121], v64 offset:57344
ds_read_b64_tr_b16 v[122:123], v64 offset:57856
v_mfma_f32_16x16x32_bf16 v[72:75], v[104:107], v[228:231], v[72:75]
ds_read_b64_tr_b16 v[124:125], v65 offset:57344
ds_read_b64_tr_b16 v[126:127], v65 offset:57856
v_mfma_f32_16x16x32_bf16 v[92:95], v[108:111], v[232:235], v[92:95]
ds_read_b64_tr_b16 v[128:129], v66 offset:57344
ds_read_b64_tr_b16 v[130:131], v66 offset:57856
v_mfma_f32_16x16x32_bf16 v[76:79], v[108:111], v[228:231], v[76:79]
ds_read_b64_tr_b16 v[132:133], v67 offset:57344
ds_read_b64_tr_b16 v[134:135], v67 offset:57856
v_mfma_f32_16x16x32_bf16 v[96:99], v[112:115], v[232:235], v[96:99]
buffer_load_dwordx4 v[224:227], v71, s[44:47], s65 offen sc1
v_mfma_f32_16x16x32_bf16 v[80:83], v[112:115], v[228:231], v[80:83]
v_mfma_f32_16x16x32_bf16 v[100:103], v[116:119], v[232:235], v[100:103]
buffer_load_dwordx4 v[220:223], v70, s[44:47], s65 offen sc1
s_add_u32 s65, s65, 131072
v_mfma_f32_16x16x32_bf16 v[84:87], v[116:119], v[228:231], v[84:87]
s_waitcnt vmcnt(10)
s_waitcnt lgkmcnt(0)
v_mfma_f32_16x16x32_bf16 v[88:91], v[120:123], v[240:243], v[88:91]
v_add_u32 v64, 65536, v64
v_add_u32 v65, 65536, v65
v_mfma_f32_16x16x32_bf16 v[72:75], v[120:123], v[236:239], v[72:75]
v_add_u32 v66, 65536, v66
v_add_u32 v67, 65536, v67
v_mfma_f32_16x16x32_bf16 v[92:95], v[124:127], v[240:243], v[92:95]
ds_read_b64_tr_b16 v[104:105], v64 offset:0
ds_read_b64_tr_b16 v[106:107], v64 offset:512
v_mfma_f32_16x16x32_bf16 v[76:79], v[124:127], v[236:239], v[76:79]
ds_read_b64_tr_b16 v[108:109], v65 offset:0
ds_read_b64_tr_b16 v[110:111], v65 offset:512
v_mfma_f32_16x16x32_bf16 v[96:99], v[128:131], v[240:243], v[96:99]
ds_read_b64_tr_b16 v[112:113], v66 offset:0
ds_read_b64_tr_b16 v[114:115], v66 offset:512
v_mfma_f32_16x16x32_bf16 v[80:83], v[128:131], v[236:239], v[80:83]
ds_read_b64_tr_b16 v[116:117], v67 offset:0
ds_read_b64_tr_b16 v[118:119], v67 offset:512
v_mfma_f32_16x16x32_bf16 v[100:103], v[132:135], v[240:243], v[100:103]
v_mfma_f32_16x16x32_bf16 v[84:87], v[132:135], v[236:239], v[84:87]
s_waitcnt vmcnt(8)
s_waitcnt lgkmcnt(0)
v_mfma_f32_16x16x32_bf16 v[88:91], v[104:107], v[200:203], v[88:91]
ds_read_b64_tr_b16 v[120:121], v64 offset:8192
ds_read_b64_tr_b16 v[122:123], v64 offset:8704
v_mfma_f32_16x16x32_bf16 v[72:75], v[104:107], v[196:199], v[72:75]
ds_read_b64_tr_b16 v[124:125], v65 offset:8192
ds_read_b64_tr_b16 v[126:127], v65 offset:8704
v_mfma_f32_16x16x32_bf16 v[92:95], v[108:111], v[200:203], v[92:95]
ds_read_b64_tr_b16 v[128:129], v66 offset:8192
ds_read_b64_tr_b16 v[130:131], v66 offset:8704
v_mfma_f32_16x16x32_bf16 v[76:79], v[108:111], v[196:199], v[76:79]
ds_read_b64_tr_b16 v[132:133], v67 offset:8192
ds_read_b64_tr_b16 v[134:135], v67 offset:8704
v_mfma_f32_16x16x32_bf16 v[96:99], v[112:115], v[200:203], v[96:99]
v_mfma_f32_16x16x32_bf16 v[80:83], v[112:115], v[196:199], v[80:83]
v_mfma_f32_16x16x32_bf16 v[100:103], v[116:119], v[200:203], v[100:103]
v_mfma_f32_16x16x32_bf16 v[84:87], v[116:119], v[196:199], v[84:87]
s_waitcnt vmcnt(4)
s_waitcnt lgkmcnt(0)
s_barrier
v_mfma_f32_16x16x32_bf16 v[88:91], v[120:123], v[208:211], v[88:91]
ds_read_b64_tr_b16 v[104:105], v64 offset:16384
ds_read_b64_tr_b16 v[106:107], v64 offset:16896
v_mfma_f32_16x16x32_bf16 v[72:75], v[120:123], v[204:207], v[72:75]
ds_read_b64_tr_b16 v[108:109], v65 offset:16384
ds_read_b64_tr_b16 v[110:111], v65 offset:16896
v_mfma_f32_16x16x32_bf16 v[92:95], v[124:127], v[208:211], v[92:95]
ds_read_b64_tr_b16 v[112:113], v66 offset:16384
ds_read_b64_tr_b16 v[114:115], v66 offset:16896
v_mfma_f32_16x16x32_bf16 v[76:79], v[124:127], v[204:207], v[76:79]
ds_read_b64_tr_b16 v[116:117], v67 offset:16384
ds_read_b64_tr_b16 v[118:119], v67 offset:16896
v_mfma_f32_16x16x32_bf16 v[96:99], v[128:131], v[208:211], v[96:99]
ds_read_b64_tr_b16 v[152:153], v3 offset:0
ds_read_b64_tr_b16 v[154:155], v3 offset:2048
v_mfma_f32_16x16x32_bf16 v[80:83], v[128:131], v[204:207], v[80:83]
ds_read_b64_tr_b16 v[156:157], v3 offset:4096
ds_read_b64_tr_b16 v[158:159], v3 offset:6144
v_mfma_f32_16x16x32_bf16 v[100:103], v[132:135], v[208:211], v[100:103]
v_mfma_f32_16x16x32_bf16 v[84:87], v[132:135], v[204:207], v[84:87]
s_waitcnt vmcnt(2)
s_waitcnt lgkmcnt(0)
v_mfma_f32_16x16x32_bf16 v[88:91], v[104:107], v[216:219], v[88:91]
ds_read_b64_tr_b16 v[120:121], v64 offset:24576
ds_read_b64_tr_b16 v[122:123], v64 offset:25088
v_mfma_f32_16x16x32_bf16 v[72:75], v[104:107], v[212:215], v[72:75]
ds_read_b64_tr_b16 v[124:125], v65 offset:24576
ds_read_b64_tr_b16 v[126:127], v65 offset:25088
v_mfma_f32_16x16x32_bf16 v[92:95], v[108:111], v[216:219], v[92:95]
ds_read_b64_tr_b16 v[128:129], v66 offset:24576
ds_read_b64_tr_b16 v[130:131], v66 offset:25088
v_mfma_f32_16x16x32_bf16 v[76:79], v[108:111], v[212:215], v[76:79]
ds_read_b64_tr_b16 v[132:133], v67 offset:24576
ds_read_b64_tr_b16 v[134:135], v67 offset:25088
v_mfma_f32_16x16x32_bf16 v[96:99], v[112:115], v[216:219], v[96:99]
v_lshlrev_b32 v160, 16, v152
v_and_b32 v161, 0xffff0000, v152
v_mfma_f32_16x16x32_bf16 v[80:83], v[112:115], v[212:215], v[80:83]
v_lshlrev_b32 v162, 16, v153
v_and_b32 v163, 0xffff0000, v153
v_mfma_f32_16x16x32_bf16 v[100:103], v[116:119], v[216:219], v[100:103]
v_lshlrev_b32 v164, 16, v154
v_and_b32 v165, 0xffff0000, v154
v_mfma_f32_16x16x32_bf16 v[84:87], v[116:119], v[212:215], v[84:87]
v_lshlrev_b32 v166, 16, v155
v_and_b32 v167, 0xffff0000, v155
s_waitcnt vmcnt(0)
s_waitcnt lgkmcnt(0)
v_mfma_f32_16x16x32_bf16 v[88:91], v[120:123], v[224:227], v[88:91]
v_lshlrev_b32 v168, 16, v156
v_and_b32 v169, 0xffff0000, v156
v_mfma_f32_16x16x32_bf16 v[92:95], v[124:127], v[224:227], v[92:95]
v_lshlrev_b32 v170, 16, v157
v_and_b32 v171, 0xffff0000, v157
v_mfma_f32_16x16x32_bf16 v[96:99], v[128:131], v[224:227], v[96:99]
v_lshlrev_b32 v172, 16, v158
v_and_b32 v173, 0xffff0000, v158
v_mfma_f32_16x16x32_bf16 v[100:103], v[132:135], v[224:227], v[100:103]
v_lshlrev_b32 v174, 16, v159
v_and_b32 v175, 0xffff0000, v159
v_mfma_f32_16x16x32_bf16 v[72:75], v[120:123], v[220:223], v[72:75]
v_pk_mul_f32 v[160:161], v[160:161], v[32:33]
v_pk_mul_f32 v[162:163], v[162:163], v[34:35]
v_mfma_f32_16x16x32_bf16 v[76:79], v[124:127], v[220:223], v[76:79]
v_pk_mul_f32 v[164:165], v[164:165], v[36:37]
v_pk_mul_f32 v[166:167], v[166:167], v[38:39]
v_mfma_f32_16x16x32_bf16 v[80:83], v[128:131], v[220:223], v[80:83]
v_pk_mul_f32 v[168:169], v[168:169], v[40:41]
v_pk_mul_f32 v[170:171], v[170:171], v[42:43]
v_mfma_f32_16x16x32_bf16 v[84:87], v[132:135], v[220:223], v[84:87]
v_pk_mul_f32 v[172:173], v[172:173], v[44:45]
v_pk_mul_f32 v[174:175], v[174:175], v[46:47]
ds_write_b128 v13, v[88:91] offset:0
ds_write_b128 v13, v[92:95] offset:1024
ds_write_b128 v13, v[96:99] offset:2048
ds_write_b128 v13, v[100:103] offset:3072
v_pk_add_f32 v[72:73], v[72:73], v[136:137]
v_pk_add_f32 v[74:75], v[74:75], v[138:139]
v_pk_add_f32 v[76:77], v[76:77], v[140:141]
v_pk_add_f32 v[78:79], v[78:79], v[142:143]
v_pk_add_f32 v[80:81], v[80:81], v[144:145]
v_pk_add_f32 v[82:83], v[82:83], v[146:147]
v_pk_add_f32 v[84:85], v[84:85], v[148:149]
v_pk_add_f32 v[86:87], v[86:87], v[150:151]
s_waitcnt lgkmcnt(0)
s_barrier
ds_read_b128 v[88:91], v14 offset:0
ds_read_b128 v[92:95], v14 offset:1024
ds_read_b128 v[96:99], v14 offset:2048
ds_read_b128 v[100:103], v14 offset:3072
s_waitcnt lgkmcnt(3)
v_pk_add_f32 v[72:73], v[72:73], v[88:89]
v_pk_add_f32 v[74:75], v[74:75], v[90:91]
s_waitcnt lgkmcnt(2)
v_pk_add_f32 v[76:77], v[76:77], v[92:93]
v_pk_add_f32 v[78:79], v[78:79], v[94:95]
v_pk_mul_f32 v[176:177], v[72:73], v[192:193]
v_pk_mul_f32 v[178:179], v[74:75], v[192:193]
v_pk_mul_f32 v[180:181], v[76:77], v[192:193]
v_pk_mul_f32 v[182:183], v[78:79], v[192:193]
v_exp_f32 v176, v176
v_exp_f32 v177, v177
v_exp_f32 v178, v178
v_exp_f32 v179, v179
v_exp_f32 v180, v180
v_exp_f32 v181, v181
v_exp_f32 v182, v182
v_exp_f32 v183, v183
v_pk_mul_f32 v[72:73], v[72:73], v[160:161]
v_pk_mul_f32 v[74:75], v[74:75], v[162:163]
v_pk_mul_f32 v[76:77], v[76:77], v[164:165]
v_pk_mul_f32 v[78:79], v[78:79], v[166:167]
v_pk_add_f32 v[176:177], v[176:177], v[194:195]
v_pk_add_f32 v[178:179], v[178:179], v[194:195]
v_pk_add_f32 v[180:181], v[180:181], v[194:195]
v_pk_add_f32 v[182:183], v[182:183], v[194:195]
v_rcp_f32 v176, v176
v_rcp_f32 v177, v177
v_rcp_f32 v178, v178
v_rcp_f32 v179, v179
v_rcp_f32 v180, v180
v_rcp_f32 v181, v181
v_rcp_f32 v182, v182
v_rcp_f32 v183, v183
v_pk_fma_f32 v[72:73], v[72:73], v[176:177], v[16:17]
v_pk_fma_f32 v[74:75], v[74:75], v[178:179], v[18:19]
v_pk_fma_f32 v[76:77], v[76:77], v[180:181], v[20:21]
v_pk_fma_f32 v[78:79], v[78:79], v[182:183], v[22:23]
v_cvt_pk_bf16_f32 v152, v72, v73
v_cvt_pk_bf16_f32 v153, v74, v75
v_cvt_pk_bf16_f32 v154, v76, v77
v_cvt_pk_bf16_f32 v155, v78, v79
ds_write_b64 v8, v[152:153]
ds_write_b64 v9, v[154:155]
s_waitcnt lgkmcnt(3)
v_pk_add_f32 v[80:81], v[80:81], v[96:97]
v_pk_add_f32 v[82:83], v[82:83], v[98:99]
s_waitcnt lgkmcnt(2)
v_pk_add_f32 v[84:85], v[84:85], v[100:101]
v_pk_add_f32 v[86:87], v[86:87], v[102:103]
v_pk_mul_f32 v[184:185], v[80:81], v[192:193]
v_pk_mul_f32 v[186:187], v[82:83], v[192:193]
v_pk_mul_f32 v[188:189], v[84:85], v[192:193]
v_pk_mul_f32 v[190:191], v[86:87], v[192:193]
v_exp_f32 v184, v184
v_exp_f32 v185, v185
v_exp_f32 v186, v186
v_exp_f32 v187, v187
v_exp_f32 v188, v188
v_exp_f32 v189, v189
v_exp_f32 v190, v190
v_exp_f32 v191, v191
v_pk_mul_f32 v[80:81], v[80:81], v[168:169]
v_pk_mul_f32 v[82:83], v[82:83], v[170:171]
v_pk_mul_f32 v[84:85], v[84:85], v[172:173]
v_pk_mul_f32 v[86:87], v[86:87], v[174:175]
v_pk_add_f32 v[184:185], v[184:185], v[194:195]
v_pk_add_f32 v[186:187], v[186:187], v[194:195]
v_pk_add_f32 v[188:189], v[188:189], v[194:195]
v_pk_add_f32 v[190:191], v[190:191], v[194:195]
v_rcp_f32 v184, v184
v_rcp_f32 v185, v185
v_rcp_f32 v186, v186
v_rcp_f32 v187, v187
v_rcp_f32 v188, v188
v_rcp_f32 v189, v189
v_rcp_f32 v190, v190
v_rcp_f32 v191, v191
v_pk_fma_f32 v[80:81], v[80:81], v[184:185], v[24:25]
v_pk_fma_f32 v[82:83], v[82:83], v[186:187], v[26:27]
v_pk_fma_f32 v[84:85], v[84:85], v[188:189], v[28:29]
v_pk_fma_f32 v[86:87], v[86:87], v[190:191], v[30:31]
v_cvt_pk_bf16_f32 v156, v80, v81
v_cvt_pk_bf16_f32 v157, v82, v83
v_cvt_pk_bf16_f32 v158, v84, v85
v_cvt_pk_bf16_f32 v159, v86, v87
ds_write_b64 v10, v[156:157]
ds_write_b64 v11, v[158:159]
s_waitcnt lgkmcnt(0)
ds_read_b128 v[176:179], v5
ds_read_b128 v[180:183], v5 offset:1024
s_waitcnt lgkmcnt(1)
buffer_store_dwordx4 v[176:179], v6, s[40:43], s64 offen
s_waitcnt lgkmcnt(0)
buffer_store_dwordx4 v[180:183], v6, s[40:43], s63 offen
L_end:
s_endpgm
.section .rodata,"a"
.p2align 6
.amdhsa_kernel recurrent_scan__ssm_conv_h3__mixer_s_mlp__prompt_kernel
  .amdhsa_next_free_vgpr 512
  .amdhsa_next_free_sgpr 102
  .amdhsa_accum_offset 256
  .amdhsa_group_segment_fixed_size 0
  .amdhsa_kernarg_size 112
  .amdhsa_user_sgpr_count 2
  .amdhsa_user_sgpr_kernarg_segment_ptr 1
  .amdhsa_system_sgpr_workgroup_id_x 1
.end_amdhsa_kernel
```
